```python
import torch

def _softmax(x, axis=-1):
    return torch.softmax(x, dim=axis)
def _gelu(x):
    return torch.nn.functional.gelu(x, approximate="tanh")
def _silu(x):
    return torch.nn.functional.silu(x)
def _sigmoid(x):
    return torch.sigmoid(x)
def _layernorm(x, axis=-1, eps=1e-5):
    m = x.mean(dim=axis, keepdim=True)
    v = x.var(dim=axis, keepdim=True, unbiased=False)
    return (x - m) / torch.sqrt(v + eps)
def _scatter_add(tgt, idx, src, axis=0):
    return tgt.clone().index_add_(axis, idx, src)
def _segment_sum(src, seg, n):
    out = torch.zeros((n,) + src.shape[1:], dtype=src.dtype)
    return out.index_add_(0, seg, src)
def _pad(x, pw):
    flat = tuple(v for pair in reversed(pw) for v in pair)
    return torch.nn.functional.pad(x, flat)

kernel_name = 'gated_mix__mha_block_cached__gqa_block_cached__decode'

def setup_inputs():

    _w = (lambda a: (lambda t: t.to(torch.bfloat16) if t.is_floating_point() else t)(torch.as_tensor(a)))
    def _A_setup():
        B, Sq, D = 8, 1, 1024
        H, Sk, Dh = 32, 4096, 128
        return {
            "x": _w((lambda *s: torch.randn(*s, dtype=torch.bfloat16) * 0.05)(B, Sq, D)),
            "k_cache": _w((lambda *s: torch.randn(*s, dtype=torch.bfloat16) * 6.4)(B, H, Sk, Dh)),
            "v_cache": _w((lambda *s: torch.randn(*s, dtype=torch.bfloat16) * 0.05)(B, H, Sk, Dh)),
            "wq": _w((lambda *s: torch.randn(*s, dtype=torch.bfloat16) * 6.4)(D, H * Dh) * (D ** -0.5)),
            "wo": _w((lambda *s: torch.randn(*s, dtype=torch.bfloat16) * 0.05)(H * Dh, D) * ((H * Dh) ** -0.5)),
        }
    _A_in = _A_setup()

    def _B_setup():
        B, Sq, D = 8, 1, 1024
        Hq, Hkv, Sk, Dh = 32, 4, 4096, 128
        assert Hq % Hkv == 0, (Hq, Hkv)
        return {
            "x": _w((lambda *s: torch.randn(*s, dtype=torch.bfloat16) * 0.05)(B, Sq, D)),
            "k_cache": _w((lambda *s: torch.randn(*s, dtype=torch.bfloat16) * 6.4)(B, Hkv, Sk, Dh)),
            "v_cache": _w((lambda *s: torch.randn(*s, dtype=torch.bfloat16) * 0.05)(B, Hkv, Sk, Dh)),
            "wq": _w((lambda *s: torch.randn(*s, dtype=torch.bfloat16) * 6.4)(D, Hq * Dh) * (D ** -0.5)),
            "wo": _w((lambda *s: torch.randn(*s, dtype=torch.bfloat16) * 0.05)(Hq * Dh, D) * ((Hq * Dh) ** -0.5)),
        }
    _B_in = _B_setup()

    return {
        "A_x": _A_in["x"],
        "A_k_cache": _A_in["k_cache"],
        "A_v_cache": _A_in["v_cache"],
        "A_wq": _A_in["wq"],
        "A_wo": _A_in["wo"],
        "B_x": _B_in["x"],
        "B_k_cache": _B_in["k_cache"],
        "B_v_cache": _B_in["v_cache"],
        "B_wq": _B_in["wq"],
        "B_wo": _B_in["wo"],
        "gate_w": _w((lambda *s: torch.randn(*s, dtype=torch.bfloat16) * 0.05)(1024) * 16.0),
    }

def reference(A_x, A_k_cache, A_v_cache, A_wq, A_wo, B_x, B_k_cache, B_v_cache, B_wq, B_wo, gate_w):
    def _A_ref(x, k_cache, v_cache, wq, wo):
        B, Sq, D = x.shape
        H, Dh = 32, 128
        q = (lambda x, *d: x.permute(*d))((x @ wq).reshape(B, Sq, H, Dh), 0, 2, 1, 3)
        scores = torch.einsum("bhqd,bhkd->bhqk", q, k_cache) * (Dh ** -0.5)
        p = _softmax(scores, axis=-1)
        o = torch.einsum("bhqk,bhkd->bhqd", p, v_cache)
        return (lambda x, *d: x.permute(*d))(o, 0, 2, 1, 3).reshape(B, Sq, H * Dh) @ wo

    def _B_ref(x, k_cache, v_cache, wq, wo):
        B, Sq, D = x.shape
        Hq, Dh = 32, 128
        Hkv = k_cache.shape[1]
        rep = Hq // Hkv
        q = (lambda x, *d: x.permute(*d))((x @ wq).reshape(B, Sq, Hq, Dh), 0, 2, 1, 3)
        k = (lambda x, n, axis: torch.repeat_interleave(x, n, dim=axis))(k_cache, rep, axis=1)
        v = (lambda x, n, axis: torch.repeat_interleave(x, n, dim=axis))(v_cache, rep, axis=1)
        scores = torch.einsum("bhqd,bhkd->bhqk", q, k) * (Dh ** -0.5)
        p = _softmax(scores, axis=-1)
        o = torch.einsum("bhqk,bhkd->bhqd", p, v)
        return (lambda x, *d: x.permute(*d))(o, 0, 2, 1, 3).reshape(B, Sq, Hq * Dh) @ wo

    x = A_x
    g = _sigmoid((x * gate_w).sum(-1, keepdims=True))
    a = _A_ref(x, A_k_cache, A_v_cache, A_wq, A_wo)
    b = _B_ref(x, B_k_cache, B_v_cache, B_wq, B_wo)
    return g * a + (1 - g) * b
```

```asm
; @launch grid=(256,1,1) block=(512,1,1) lds=163840
.amdgcn_target "amdgcn-amd-amdhsa--gfx950"
.text
.globl gated_mix__mha_block_cached__gqa_block_cached__decode_kernel
.p2align 8
.type gated_mix__mha_block_cached__gqa_block_cached__decode_kernel,@function
gated_mix__mha_block_cached__gqa_block_cached__decode_kernel:
    s_cmp_ge_u32 s2, 256
    s_cbranch_scc1 L_end
    s_load_dwordx16 s[40:55], s[0:1], 0
    s_load_dwordx8 s[56:63], s[0:1], 64
    s_load_dwordx4 s[64:67], s[0:1], 96
    v_lshrrev_b32 v1, 6, v0
    v_and_b32 v0, 63, v0
    v_readfirstlane_b32 s3, v1
    s_lshr_b32 s4, s2, 5
    s_and_b32 s5, s2, 31
    s_lshr_b32 s6, s5, 3
    s_and_b32 s7, s5, 7
    s_mov_b32 s72, 0x3e0293ee
    v_lshrrev_b32 v1, 4, v0
    v_and_b32 v2, 15, v0
    v_lshlrev_b32 v3, 1, v1
    v_xor_b32 v3, v3, v2
    v_lshlrev_b32 v3, 4, v3
    s_mov_b32 s11, 0x20000
    s_mov_b32 s15, 0x20000
    s_mov_b32 s27, 0x20000
    s_mov_b32 s35, 0x20000
    s_lshl_b32 s19, s5, 3
    s_add_u32 s19, s19, s4
    s_lshl_b32 s76, s19, 8
    s_lshl_b32 s19, s4, 5
    s_add_u32 s19, s19, s5
    s_lshl_b32 s78, s19, 8
    v_lshlrev_b32 v6, 4, v0
    v_lshlrev_b32 v7, 2, v0
    s_cmp_ge_u32 s3, 4
    s_cbranch_scc1 L_ctrl
    v_lshl_add_u32 v4, v1, 8, v3
    v_xor_b32 v5, 0x80, v4
    s_lshl_b32 s21, s3, 15
    s_lshl_b32 s16, s4, 5
    s_add_u32 s16, s16, s5
    s_lshl_b32 s16, s16, 20
    s_mul_i32 s19, s3, 4096
    s_add_u32 s16, s16, s19
    s_add_u32 s17, s16, 16384
    s_mov_b32 s39, 0x26262626
    s_mov_b32 s36, 0xe080600
    s_mov_b32 s37, 0x1e181610
    s_cmp_ge_u32 s3, 3
    s_cmov_b32 s39, 0x44444444
    s_cmov_b32 s36, 0xc080400
    s_cmov_b32 s37, 0x1c181410
    s_lshl_b32 s23, s7, 2
    s_lshr_b32 s39, s39, s23
    s_and_b32 s39, s39, 15
    s_lshl_b32 s23, s7, 3
    s_lshr_b64 s[36:37], s[36:37], s23
    s_and_b32 s23, s36, 255
    s_lshl_b32 s23, s23, 15
    s_lshl_b32 s22, s4, 2
    s_add_u32 s22, s22, s6
    s_lshl_b32 s22, s22, 20
    s_add_u32 s22, s22, s23
    s_add_u32 s22, s22, s19
    s_add_u32 s23, s39, 30
    s_add_u32 s39, s39, 16
    s_sub_u32 s38, s39, 2
    s_mov_b32 s36, 14
    s_mov_b32 s37, 16
    s_waitcnt lgkmcnt(0)
    s_mov_b32 s8, s42
    s_mov_b32 s9, s43
    s_mov_b32 s10, 0x10000000
    s_mov_b32 s12, s44
    s_mov_b32 s13, s45
    s_mov_b32 s14, 0x10000000
    v_mov_b32 v22, 0xf0000
    global_load_dword v22, v22, s[66:67] sc1
    v_mov_b32 v8, -1
    v_mov_b32 v9, -1
    v_mov_b32 v10, -1
    v_mov_b32 v11, -1
    s_sub_u32 s19, s3, 0
    s_cmp_ge_u32 s19, 2
    s_cbranch_scc1 L_noclr
    s_cmp_eq_u32 s19, 1
    s_cbranch_scc1 L_clr1
    s_lshl_b32 s19, s78, 4
    s_add_u32 s19, s19, 2097152
    v_add_u32 v12, s19, v6
    global_store_dwordx4 v12, v[8:11], s[66:67] offset:0 sc1
    global_store_dwordx4 v12, v[8:11], s[66:67] offset:1024 sc1
    global_store_dwordx4 v12, v[8:11], s[66:67] offset:2048 sc1
    global_store_dwordx4 v12, v[8:11], s[66:67] offset:3072 sc1
    s_lshr_b32 s19, s76, 0
    s_add_u32 s19, s19, 6291456
    v_add_u32 v12, s19, v7
    s_mov_b64 exec, -1
    global_store_dword v12, v8, s[66:67] sc1
    s_mov_b64 exec, -1
    s_lshr_b32 s19, s76, 0
    s_add_u32 s19, s19, 6356992
    v_add_u32 v12, s19, v7
    s_mov_b64 exec, -1
    global_store_dword v12, v8, s[66:67] sc1
    s_mov_b64 exec, -1
    s_lshr_b32 s19, s76, 5
    s_add_u32 s19, s19, 6422528
    v_add_u32 v12, s19, v7
    s_mov_b64 exec, 3
    global_store_dword v12, v8, s[66:67] sc1
    s_mov_b64 exec, -1
    s_branch L_clr2
L_clr1:
    s_lshl_b32 s19, s78, 4
    s_add_u32 s19, s19, 7340032
    v_add_u32 v12, s19, v6
    global_store_dwordx4 v12, v[8:11], s[66:67] offset:0 sc1
    global_store_dwordx4 v12, v[8:11], s[66:67] offset:1024 sc1
    global_store_dwordx4 v12, v[8:11], s[66:67] offset:2048 sc1
    global_store_dwordx4 v12, v[8:11], s[66:67] offset:3072 sc1
    s_lshl_b32 s19, s78, 4
    s_add_u32 s19, s19, 4194304
    v_add_u32 v12, s19, v6
    global_store_dwordx4 v12, v[8:11], s[66:67] offset:0 sc1
    global_store_dwordx4 v12, v[8:11], s[66:67] offset:1024 sc1
    global_store_dwordx4 v12, v[8:11], s[66:67] offset:2048 sc1
    global_store_dwordx4 v12, v[8:11], s[66:67] offset:3072 sc1
    s_lshr_b32 s19, s78, 0
    s_add_u32 s19, s19, 3145728
    v_add_u32 v12, s19, v7
    s_mov_b64 exec, -1
    global_store_dword v12, v8, s[66:67] sc1
    s_mov_b64 exec, -1
    s_lshr_b32 s19, s78, 2
    s_add_u32 s19, s19, 5242880
    v_add_u32 v12, s19, v7
    s_mov_b64 exec, 65535
    global_store_dword v12, v8, s[66:67] sc1
    s_mov_b64 exec, -1
L_clr2:
L_noclr:
    s_lshr_b32 s19, s78, 5
    s_lshl_b32 s20, s3, 2
    s_add_u32 s19, s19, s20
    s_add_u32 s19, s19, 917504
    v_mov_b32 v23, s19
    s_add_u32 m0, s21, 0
    s_nop 0
    buffer_load_dwordx4 v4, s[8:11], s16 offen offset:0 nt lds
    buffer_load_dwordx4 v5, s[8:11], s16 offen offset:1024 nt lds
    buffer_load_dwordx4 v4, s[8:11], s16 offen offset:2048 nt lds
    buffer_load_dwordx4 v5, s[8:11], s16 offen offset:3072 nt lds
    s_add_u32 m0, s21, 4096
    s_nop 0
    buffer_load_dwordx4 v4, s[8:11], s17 offen offset:0 nt lds
    buffer_load_dwordx4 v5, s[8:11], s17 offen offset:1024 nt lds
    buffer_load_dwordx4 v4, s[8:11], s17 offen offset:2048 nt lds
    buffer_load_dwordx4 v5, s[8:11], s17 offen offset:3072 nt lds
    s_barrier
    s_add_u32 m0, s21, 8192
    s_nop 0
    buffer_load_dwordx4 v4, s[12:15], s16 offen offset:0 nt lds
    buffer_load_dwordx4 v5, s[12:15], s16 offen offset:1024 nt lds
    buffer_load_dwordx4 v4, s[12:15], s16 offen offset:2048 nt lds
    buffer_load_dwordx4 v5, s[12:15], s16 offen offset:3072 nt lds
    s_add_u32 m0, s21, 12288
    s_nop 0
    buffer_load_dwordx4 v4, s[12:15], s17 offen offset:0 nt lds
    buffer_load_dwordx4 v5, s[12:15], s17 offen offset:1024 nt lds
    buffer_load_dwordx4 v4, s[12:15], s17 offen offset:2048 nt lds
    buffer_load_dwordx4 v5, s[12:15], s17 offen offset:3072 nt lds
    s_add_u32 m0, s21, 16384
    s_add_u32 s19, s16, 32768
    buffer_load_dwordx4 v4, s[8:11], s19 offen offset:0 nt lds
    buffer_load_dwordx4 v5, s[8:11], s19 offen offset:1024 nt lds
    buffer_load_dwordx4 v4, s[8:11], s19 offen offset:2048 nt lds
    buffer_load_dwordx4 v5, s[8:11], s19 offen offset:3072 nt lds
    s_add_u32 m0, s21, 20480
    s_add_u32 s19, s17, 32768
    buffer_load_dwordx4 v4, s[8:11], s19 offen offset:0 nt lds
    buffer_load_dwordx4 v5, s[8:11], s19 offen offset:1024 nt lds
    buffer_load_dwordx4 v4, s[8:11], s19 offen offset:2048 nt lds
    buffer_load_dwordx4 v5, s[8:11], s19 offen offset:3072 nt lds
    s_add_u32 m0, s21, 24576
    s_add_u32 s19, s16, 32768
    buffer_load_dwordx4 v4, s[12:15], s19 offen offset:0 nt lds
    buffer_load_dwordx4 v5, s[12:15], s19 offen offset:1024 nt lds
    buffer_load_dwordx4 v4, s[12:15], s19 offen offset:2048 nt lds
    buffer_load_dwordx4 v5, s[12:15], s19 offen offset:3072 nt lds
    s_add_u32 m0, s21, 28672
    s_add_u32 s19, s17, 32768
    buffer_load_dwordx4 v4, s[12:15], s19 offen offset:0 nt lds
    buffer_load_dwordx4 v5, s[12:15], s19 offen offset:1024 nt lds
    buffer_load_dwordx4 v4, s[12:15], s19 offen offset:2048 nt lds
    buffer_load_dwordx4 v5, s[12:15], s19 offen offset:3072 nt lds
    v_and_b32 v6, 7, v2
    v_lshlrev_b32 v6, 1, v6
    v_xor_b32 v6, v6, v1
    v_lshlrev_b32 v6, 4, v6
    v_lshl_add_u32 v6, v2, 8, v6
    v_add_u32 v8, s21, v6
    v_xor_b32 v9, 64, v8
    v_xor_b32 v10, 128, v8
    v_xor_b32 v11, 192, v8
    v_lshrrev_b32 v6, 2, v2
    v_lshl_add_u32 v6, v1, 2, v6
    v_and_b32 v7, 7, v6
    v_lshlrev_b32 v7, 5, v7
    v_lshl_add_u32 v6, v6, 8, v7
    v_and_b32 v7, 3, v0
    v_lshl_add_u32 v6, v7, 3, v6
    v_add_u32 v6, s21, v6
    v_add_u32 v12, 8192, v6
    v_xor_b32 v13, 32, v12
    v_xor_b32 v14, 64, v12
    v_xor_b32 v15, 96, v12
    v_xor_b32 v16, 128, v12
    v_xor_b32 v17, 160, v12
    v_xor_b32 v18, 192, v12
    v_xor_b32 v19, 224, v12
    v_lshlrev_b32 v20, 4, v1
    v_and_b32 v21, 7, v0
    v_lshl_add_u32 v21, v21, 8, v20
    s_add_u32 s16, s16, 65536
    s_add_u32 s17, s17, 65536
    v_mov_b32 v116, 0
    v_mov_b32 v117, 0
    v_mov_b32 v118, 0
    v_mov_b32 v119, 0
    v_mov_b32 v120, 0
    v_mov_b32 v121, 0
    v_mov_b32 v122, 0
    v_mov_b32 v123, 0
    v_mov_b32 v124, 0
    v_mov_b32 v125, 0
    v_mov_b32 v126, 0
    v_mov_b32 v127, 0
    v_mov_b32 v128, 0
    v_mov_b32 v129, 0
    v_mov_b32 v130, 0
    v_mov_b32 v131, 0
    v_mov_b32 v132, 0
    v_mov_b32 v133, 0
    v_mov_b32 v134, 0
    v_mov_b32 v135, 0
    v_mov_b32 v136, 0
    v_mov_b32 v137, 0
    v_mov_b32 v138, 0
    v_mov_b32 v139, 0
    v_mov_b32 v140, 0
    v_mov_b32 v141, 0
    v_mov_b32 v142, 0
    v_mov_b32 v143, 0
    v_mov_b32 v144, 0
    v_mov_b32 v145, 0
    v_mov_b32 v146, 0
    v_mov_b32 v147, 0
    v_mov_b32 v148, 0xff7fffff
    v_mov_b32 v149, 0
    s_waitcnt vmcnt(32)
    s_cmp_ge_u32 s3, 2
    s_cbranch_scc1 L_nosig
    v_and_b32 v22, 0xff, v22
    v_add_u32 v24, 0xffffff02, v22
    v_min_u32 v22, v22, v24
    v_add_u32 v22, 1, v22
    v_or_b32 v22, 0x5a5a5a00, v22
    s_mov_b64 exec, 1
    global_store_dword v23, v22, s[66:67] sc1
    s_mov_b64 exec, -1
    s_nop 1
L_nosig:
    v_add_u32 v22, 149888, v20
    v_add_u32 v23, 150144, v21
    s_barrier
    ds_read_b128 v[24:27], v22 offset:0
    ds_read_b128 v[28:31], v22 offset:64
    ds_read_b128 v[32:35], v22 offset:128
    ds_read_b128 v[36:39], v22 offset:192
    s_mov_b32 s20, 0
L_loop:
    s_cmp_eq_u32 s20, s36
    s_cbranch_scc1 L_evIB
L_rIB:
    s_cmp_eq_u32 s20, s37
    s_cbranch_scc1 L_evB0
L_rB0:
    s_cmp_eq_u32 s20, s38
    s_cbranch_scc1 L_evIA
L_rIA:
    s_cmp_eq_u32 s20, s39
    s_cbranch_scc1 L_evB1
L_rB1:
    s_waitcnt vmcnt(24)
    ds_read_b128 v[40:43], v8 offset:0
    ds_read_b128 v[44:47], v9 offset:0
    ds_read_b128 v[48:51], v10 offset:0
    ds_read_b128 v[52:55], v11 offset:0
    ds_read_b128 v[56:59], v8 offset:4096
    ds_read_b128 v[60:63], v9 offset:4096
    ds_read_b128 v[64:67], v10 offset:4096
    ds_read_b128 v[68:71], v11 offset:4096
    s_waitcnt lgkmcnt(0)
    s_add_u32 m0, s21, 0
    s_nop 0
    buffer_load_dwordx4 v4, s[8:11], s16 offen offset:0 nt lds
    buffer_load_dwordx4 v5, s[8:11], s16 offen offset:1024 nt lds
    buffer_load_dwordx4 v4, s[8:11], s16 offen offset:2048 nt lds
    buffer_load_dwordx4 v5, s[8:11], s16 offen offset:3072 nt lds
    s_add_u32 m0, s21, 4096
    s_nop 0
    buffer_load_dwordx4 v4, s[8:11], s17 offen offset:0 nt lds
    buffer_load_dwordx4 v5, s[8:11], s17 offen offset:1024 nt lds
    buffer_load_dwordx4 v4, s[8:11], s17 offen offset:2048 nt lds
    buffer_load_dwordx4 v5, s[8:11], s17 offen offset:3072 nt lds
    v_mfma_f32_16x16x32_bf16 v[104:107], v[40:43], v[24:27], 0
    v_mfma_f32_16x16x32_bf16 v[108:111], v[56:59], v[24:27], 0
    v_mfma_f32_16x16x32_bf16 v[104:107], v[44:47], v[28:31], v[104:107]
    v_mfma_f32_16x16x32_bf16 v[108:111], v[60:63], v[28:31], v[108:111]
    v_mfma_f32_16x16x32_bf16 v[104:107], v[48:51], v[32:35], v[104:107]
    v_mfma_f32_16x16x32_bf16 v[108:111], v[64:67], v[32:35], v[108:111]
    v_mfma_f32_16x16x32_bf16 v[104:107], v[52:55], v[36:39], v[104:107]
    v_mfma_f32_16x16x32_bf16 v[108:111], v[68:71], v[36:39], v[108:111]
    s_waitcnt vmcnt(24)
    ds_read_b64_tr_b16 v[72:73], v12 offset:0
    ds_read_b64_tr_b16 v[74:75], v12 offset:4096
    ds_read_b64_tr_b16 v[76:77], v13 offset:0
    ds_read_b64_tr_b16 v[78:79], v13 offset:4096
    ds_read_b64_tr_b16 v[80:81], v14 offset:0
    ds_read_b64_tr_b16 v[82:83], v14 offset:4096
    ds_read_b64_tr_b16 v[84:85], v15 offset:0
    ds_read_b64_tr_b16 v[86:87], v15 offset:4096
    ds_read_b64_tr_b16 v[88:89], v16 offset:0
    ds_read_b64_tr_b16 v[90:91], v16 offset:4096
    ds_read_b64_tr_b16 v[92:93], v17 offset:0
    ds_read_b64_tr_b16 v[94:95], v17 offset:4096
    ds_read_b64_tr_b16 v[96:97], v18 offset:0
    ds_read_b64_tr_b16 v[98:99], v18 offset:4096
    ds_read_b64_tr_b16 v[100:101], v19 offset:0
    ds_read_b64_tr_b16 v[102:103], v19 offset:4096
    v_max3_f32 v150, v104, v105, v106
    v_max3_f32 v186, v107, v108, v109
    v_max3_f32 v150, v150, v110, v111
    v_max3_f32 v150, v150, v186, v148
    v_mov_b32 v151, v150
    s_nop 1
    v_permlane32_swap_b32 v150, v151
    s_nop 1
    v_max_f32 v150, v150, v151
    v_mov_b32 v151, v150
    s_nop 1
    v_permlane16_swap_b32 v150, v151
    s_nop 1
    v_max_f32 v150, v150, v151
    v_cmp_neq_f32 vcc, v150, v148
    v_mul_f32 v187, s72, v150
    s_cbranch_vccz L_sk1
    v_sub_f32 v186, v148, v150
    v_mul_f32 v186, s72, v186
    v_exp_f32 v186, v186
    v_mov_b32 v148, v150
    v_mul_f32 v149, v149, v186
    v_mul_f32 v116, v116, v186
    v_mul_f32 v117, v117, v186
    v_mul_f32 v118, v118, v186
    v_mul_f32 v119, v119, v186
    v_mul_f32 v120, v120, v186
    v_mul_f32 v121, v121, v186
    v_mul_f32 v122, v122, v186
    v_mul_f32 v123, v123, v186
    v_mul_f32 v124, v124, v186
    v_mul_f32 v125, v125, v186
    v_mul_f32 v126, v126, v186
    v_mul_f32 v127, v127, v186
    v_mul_f32 v128, v128, v186
    v_mul_f32 v129, v129, v186
    v_mul_f32 v130, v130, v186
    v_mul_f32 v131, v131, v186
    v_mul_f32 v132, v132, v186
    v_mul_f32 v133, v133, v186
    v_mul_f32 v134, v134, v186
    v_mul_f32 v135, v135, v186
    v_mul_f32 v136, v136, v186
    v_mul_f32 v137, v137, v186
    v_mul_f32 v138, v138, v186
    v_mul_f32 v139, v139, v186
    v_mul_f32 v140, v140, v186
    v_mul_f32 v141, v141, v186
    v_mul_f32 v142, v142, v186
    v_mul_f32 v143, v143, v186
    v_mul_f32 v144, v144, v186
    v_mul_f32 v145, v145, v186
    v_mul_f32 v146, v146, v186
    v_mul_f32 v147, v147, v186
L_sk1:
    v_fma_f32 v104, v104, s72, -v187
    v_fma_f32 v105, v105, s72, -v187
    v_fma_f32 v106, v106, s72, -v187
    v_fma_f32 v107, v107, s72, -v187
    v_fma_f32 v108, v108, s72, -v187
    v_fma_f32 v109, v109, s72, -v187
    v_fma_f32 v110, v110, s72, -v187
    v_fma_f32 v111, v111, s72, -v187
    v_exp_f32 v104, v104
    v_exp_f32 v105, v105
    v_exp_f32 v106, v106
    v_exp_f32 v107, v107
    v_exp_f32 v108, v108
    v_exp_f32 v109, v109
    v_exp_f32 v110, v110
    v_exp_f32 v111, v111
    v_add_f32 v150, v104, v105
    v_add_f32 v186, v106, v107
    v_cvt_pk_bf16_f32 v112, v104, v105
    v_cvt_pk_bf16_f32 v113, v106, v107
    v_cvt_pk_bf16_f32 v114, v108, v109
    v_cvt_pk_bf16_f32 v115, v110, v111
    v_add_f32 v150, v150, v108
    v_add_f32 v186, v186, v109
    v_add_f32 v150, v150, v110
    v_add_f32 v186, v186, v111
    v_add_f32 v149, v149, v150
    v_add_f32 v149, v149, v186
    s_waitcnt lgkmcnt(0)
    s_add_u32 m0, s21, 8192
    s_nop 0
    buffer_load_dwordx4 v4, s[12:15], s16 offen offset:0 nt lds
    buffer_load_dwordx4 v5, s[12:15], s16 offen offset:1024 nt lds
    buffer_load_dwordx4 v4, s[12:15], s16 offen offset:2048 nt lds
    buffer_load_dwordx4 v5, s[12:15], s16 offen offset:3072 nt lds
    s_add_u32 m0, s21, 12288
    s_nop 0
    buffer_load_dwordx4 v4, s[12:15], s17 offen offset:0 nt lds
    buffer_load_dwordx4 v5, s[12:15], s17 offen offset:1024 nt lds
    buffer_load_dwordx4 v4, s[12:15], s17 offen offset:2048 nt lds
    buffer_load_dwordx4 v5, s[12:15], s17 offen offset:3072 nt lds
    s_add_u32 s16, s16, 32768
    s_add_u32 s17, s17, 32768
    v_mfma_f32_16x16x32_bf16 v[116:119], v[72:75], v[112:115], v[116:119]
    v_mfma_f32_16x16x32_bf16 v[120:123], v[76:79], v[112:115], v[120:123]
    v_mfma_f32_16x16x32_bf16 v[124:127], v[80:83], v[112:115], v[124:127]
    v_mfma_f32_16x16x32_bf16 v[128:131], v[84:87], v[112:115], v[128:131]
    v_mfma_f32_16x16x32_bf16 v[132:135], v[88:91], v[112:115], v[132:135]
    v_mfma_f32_16x16x32_bf16 v[136:139], v[92:95], v[112:115], v[136:139]
    v_mfma_f32_16x16x32_bf16 v[140:143], v[96:99], v[112:115], v[140:143]
    v_mfma_f32_16x16x32_bf16 v[144:147], v[100:103], v[112:115], v[144:147]
    s_waitcnt vmcnt(24)
    ds_read_b128 v[40:43], v8 offset:16384
    ds_read_b128 v[44:47], v9 offset:16384
    ds_read_b128 v[48:51], v10 offset:16384
    ds_read_b128 v[52:55], v11 offset:16384
    ds_read_b128 v[56:59], v8 offset:20480
    ds_read_b128 v[60:63], v9 offset:20480
    ds_read_b128 v[64:67], v10 offset:20480
    ds_read_b128 v[68:71], v11 offset:20480
    s_waitcnt lgkmcnt(0)
    s_add_u32 m0, s21, 16384
    s_nop 0
    buffer_load_dwordx4 v4, s[8:11], s16 offen offset:0 nt lds
    buffer_load_dwordx4 v5, s[8:11], s16 offen offset:1024 nt lds
    buffer_load_dwordx4 v4, s[8:11], s16 offen offset:2048 nt lds
    buffer_load_dwordx4 v5, s[8:11], s16 offen offset:3072 nt lds
    s_add_u32 m0, s21, 20480
    s_nop 0
    buffer_load_dwordx4 v4, s[8:11], s17 offen offset:0 nt lds
    buffer_load_dwordx4 v5, s[8:11], s17 offen offset:1024 nt lds
    buffer_load_dwordx4 v4, s[8:11], s17 offen offset:2048 nt lds
    buffer_load_dwordx4 v5, s[8:11], s17 offen offset:3072 nt lds
    v_mfma_f32_16x16x32_bf16 v[104:107], v[40:43], v[24:27], 0
    v_mfma_f32_16x16x32_bf16 v[108:111], v[56:59], v[24:27], 0
    v_mfma_f32_16x16x32_bf16 v[104:107], v[44:47], v[28:31], v[104:107]
    v_mfma_f32_16x16x32_bf16 v[108:111], v[60:63], v[28:31], v[108:111]
    v_mfma_f32_16x16x32_bf16 v[104:107], v[48:51], v[32:35], v[104:107]
    v_mfma_f32_16x16x32_bf16 v[108:111], v[64:67], v[32:35], v[108:111]
    v_mfma_f32_16x16x32_bf16 v[104:107], v[52:55], v[36:39], v[104:107]
    v_mfma_f32_16x16x32_bf16 v[108:111], v[68:71], v[36:39], v[108:111]
    s_waitcnt vmcnt(24)
    ds_read_b64_tr_b16 v[72:73], v12 offset:16384
    ds_read_b64_tr_b16 v[74:75], v12 offset:20480
    ds_read_b64_tr_b16 v[76:77], v13 offset:16384
    ds_read_b64_tr_b16 v[78:79], v13 offset:20480
    ds_read_b64_tr_b16 v[80:81], v14 offset:16384
    ds_read_b64_tr_b16 v[82:83], v14 offset:20480
    ds_read_b64_tr_b16 v[84:85], v15 offset:16384
    ds_read_b64_tr_b16 v[86:87], v15 offset:20480
    ds_read_b64_tr_b16 v[88:89], v16 offset:16384
    ds_read_b64_tr_b16 v[90:91], v16 offset:20480
    ds_read_b64_tr_b16 v[92:93], v17 offset:16384
    ds_read_b64_tr_b16 v[94:95], v17 offset:20480
    ds_read_b64_tr_b16 v[96:97], v18 offset:16384
    ds_read_b64_tr_b16 v[98:99], v18 offset:20480
    ds_read_b64_tr_b16 v[100:101], v19 offset:16384
    ds_read_b64_tr_b16 v[102:103], v19 offset:20480
    v_max3_f32 v150, v104, v105, v106
    v_max3_f32 v186, v107, v108, v109
    v_max3_f32 v150, v150, v110, v111
    v_max3_f32 v150, v150, v186, v148
    v_mov_b32 v151, v150
    s_nop 1
    v_permlane32_swap_b32 v150, v151
    s_nop 1
    v_max_f32 v150, v150, v151
    v_mov_b32 v151, v150
    s_nop 1
    v_permlane16_swap_b32 v150, v151
    s_nop 1
    v_max_f32 v150, v150, v151
    v_cmp_neq_f32 vcc, v150, v148
    v_mul_f32 v187, s72, v150
    s_cbranch_vccz L_sk2
    v_sub_f32 v186, v148, v150
    v_mul_f32 v186, s72, v186
    v_exp_f32 v186, v186
    v_mov_b32 v148, v150
    v_mul_f32 v149, v149, v186
    v_mul_f32 v116, v116, v186
    v_mul_f32 v117, v117, v186
    v_mul_f32 v118, v118, v186
    v_mul_f32 v119, v119, v186
    v_mul_f32 v120, v120, v186
    v_mul_f32 v121, v121, v186
    v_mul_f32 v122, v122, v186
    v_mul_f32 v123, v123, v186
    v_mul_f32 v124, v124, v186
    v_mul_f32 v125, v125, v186
    v_mul_f32 v126, v126, v186
    v_mul_f32 v127, v127, v186
    v_mul_f32 v128, v128, v186
    v_mul_f32 v129, v129, v186
    v_mul_f32 v130, v130, v186
    v_mul_f32 v131, v131, v186
    v_mul_f32 v132, v132, v186
    v_mul_f32 v133, v133, v186
    v_mul_f32 v134, v134, v186
    v_mul_f32 v135, v135, v186
    v_mul_f32 v136, v136, v186
    v_mul_f32 v137, v137, v186
    v_mul_f32 v138, v138, v186
    v_mul_f32 v139, v139, v186
    v_mul_f32 v140, v140, v186
    v_mul_f32 v141, v141, v186
    v_mul_f32 v142, v142, v186
    v_mul_f32 v143, v143, v186
    v_mul_f32 v144, v144, v186
    v_mul_f32 v145, v145, v186
    v_mul_f32 v146, v146, v186
    v_mul_f32 v147, v147, v186
L_sk2:
    v_fma_f32 v104, v104, s72, -v187
    v_fma_f32 v105, v105, s72, -v187
    v_fma_f32 v106, v106, s72, -v187
    v_fma_f32 v107, v107, s72, -v187
    v_fma_f32 v108, v108, s72, -v187
    v_fma_f32 v109, v109, s72, -v187
    v_fma_f32 v110, v110, s72, -v187
    v_fma_f32 v111, v111, s72, -v187
    v_exp_f32 v104, v104
    v_exp_f32 v105, v105
    v_exp_f32 v106, v106
    v_exp_f32 v107, v107
    v_exp_f32 v108, v108
    v_exp_f32 v109, v109
    v_exp_f32 v110, v110
    v_exp_f32 v111, v111
    v_add_f32 v150, v104, v105
    v_add_f32 v186, v106, v107
    v_cvt_pk_bf16_f32 v112, v104, v105
    v_cvt_pk_bf16_f32 v113, v106, v107
    v_cvt_pk_bf16_f32 v114, v108, v109
    v_cvt_pk_bf16_f32 v115, v110, v111
    v_add_f32 v150, v150, v108
    v_add_f32 v186, v186, v109
    v_add_f32 v150, v150, v110
    v_add_f32 v186, v186, v111
    v_add_f32 v149, v149, v150
    v_add_f32 v149, v149, v186
    s_waitcnt lgkmcnt(0)
    s_add_u32 m0, s21, 24576
    s_nop 0
    buffer_load_dwordx4 v4, s[12:15], s16 offen offset:0 nt lds
    buffer_load_dwordx4 v5, s[12:15], s16 offen offset:1024 nt lds
    buffer_load_dwordx4 v4, s[12:15], s16 offen offset:2048 nt lds
    buffer_load_dwordx4 v5, s[12:15], s16 offen offset:3072 nt lds
    s_add_u32 m0, s21, 28672
    s_nop 0
    buffer_load_dwordx4 v4, s[12:15], s17 offen offset:0 nt lds
    buffer_load_dwordx4 v5, s[12:15], s17 offen offset:1024 nt lds
    buffer_load_dwordx4 v4, s[12:15], s17 offen offset:2048 nt lds
    buffer_load_dwordx4 v5, s[12:15], s17 offen offset:3072 nt lds
    s_add_u32 s16, s16, 32768
    s_add_u32 s17, s17, 32768
    v_mfma_f32_16x16x32_bf16 v[116:119], v[72:75], v[112:115], v[116:119]
    v_mfma_f32_16x16x32_bf16 v[120:123], v[76:79], v[112:115], v[120:123]
    v_mfma_f32_16x16x32_bf16 v[124:127], v[80:83], v[112:115], v[124:127]
    v_mfma_f32_16x16x32_bf16 v[128:131], v[84:87], v[112:115], v[128:131]
    v_mfma_f32_16x16x32_bf16 v[132:135], v[88:91], v[112:115], v[132:135]
    v_mfma_f32_16x16x32_bf16 v[136:139], v[92:95], v[112:115], v[136:139]
    v_mfma_f32_16x16x32_bf16 v[140:143], v[96:99], v[112:115], v[140:143]
    v_mfma_f32_16x16x32_bf16 v[144:147], v[100:103], v[112:115], v[144:147]
    s_add_u32 s20, s20, 2
    s_cmp_lt_u32 s20, s23
    s_cbranch_scc1 L_loop
    v_lshl_add_u32 v6, v1, 11, v3
    v_xor_b32 v7, 0x80, v6
    s_lshl_b32 s18, s5, 18
    s_lshl_b32 s19, s3, 16
    s_add_u32 s18, s18, s19
    s_lshl_b32 s19, s4, 8
    s_add_u32 s18, s18, s19
    s_waitcnt vmcnt(24)
    ds_read_b128 v[40:43], v8 offset:0
    ds_read_b128 v[44:47], v9 offset:0
    ds_read_b128 v[48:51], v10 offset:0
    ds_read_b128 v[52:55], v11 offset:0
    ds_read_b128 v[56:59], v8 offset:4096
    ds_read_b128 v[60:63], v9 offset:4096
    ds_read_b128 v[64:67], v10 offset:4096
    ds_read_b128 v[68:71], v11 offset:4096
    s_waitcnt lgkmcnt(0)
    s_mov_b32 s24, s48
    s_mov_b32 s25, s49
    s_mov_b32 s26, 0x800000
    s_add_u32 m0, s21, 0
    s_add_u32 s19, s18, 0
    buffer_load_dwordx4 v6, s[24:27], s19 offen nt lds
    s_add_u32 m0, s21, 1024
    s_add_u32 s19, s18, 8192
    buffer_load_dwordx4 v7, s[24:27], s19 offen nt lds
    s_add_u32 m0, s21, 2048
    s_add_u32 s19, s18, 16384
    buffer_load_dwordx4 v6, s[24:27], s19 offen nt lds
    s_add_u32 m0, s21, 3072
    s_add_u32 s19, s18, 24576
    buffer_load_dwordx4 v7, s[24:27], s19 offen nt lds
    s_add_u32 m0, s21, 4096
    s_add_u32 s19, s18, 32768
    buffer_load_dwordx4 v6, s[24:27], s19 offen nt lds
    s_add_u32 m0, s21, 5120
    s_add_u32 s19, s18, 40960
    buffer_load_dwordx4 v7, s[24:27], s19 offen nt lds
    s_add_u32 m0, s21, 6144
    s_add_u32 s19, s18, 49152
    buffer_load_dwordx4 v6, s[24:27], s19 offen nt lds
    s_add_u32 m0, s21, 7168
    s_add_u32 s19, s18, 57344
    buffer_load_dwordx4 v7, s[24:27], s19 offen nt lds
    v_mfma_f32_16x16x32_bf16 v[104:107], v[40:43], v[24:27], 0
    v_mfma_f32_16x16x32_bf16 v[108:111], v[56:59], v[24:27], 0
    v_mfma_f32_16x16x32_bf16 v[104:107], v[44:47], v[28:31], v[104:107]
    v_mfma_f32_16x16x32_bf16 v[108:111], v[60:63], v[28:31], v[108:111]
    v_mfma_f32_16x16x32_bf16 v[104:107], v[48:51], v[32:35], v[104:107]
    v_mfma_f32_16x16x32_bf16 v[108:111], v[64:67], v[32:35], v[108:111]
    v_mfma_f32_16x16x32_bf16 v[104:107], v[52:55], v[36:39], v[104:107]
    v_mfma_f32_16x16x32_bf16 v[108:111], v[68:71], v[36:39], v[108:111]
    s_waitcnt vmcnt(24)
    ds_read_b64_tr_b16 v[72:73], v12 offset:0
    ds_read_b64_tr_b16 v[74:75], v12 offset:4096
    ds_read_b64_tr_b16 v[76:77], v13 offset:0
    ds_read_b64_tr_b16 v[78:79], v13 offset:4096
    ds_read_b64_tr_b16 v[80:81], v14 offset:0
    ds_read_b64_tr_b16 v[82:83], v14 offset:4096
    ds_read_b64_tr_b16 v[84:85], v15 offset:0
    ds_read_b64_tr_b16 v[86:87], v15 offset:4096
    ds_read_b64_tr_b16 v[88:89], v16 offset:0
    ds_read_b64_tr_b16 v[90:91], v16 offset:4096
    ds_read_b64_tr_b16 v[92:93], v17 offset:0
    ds_read_b64_tr_b16 v[94:95], v17 offset:4096
    ds_read_b64_tr_b16 v[96:97], v18 offset:0
    ds_read_b64_tr_b16 v[98:99], v18 offset:4096
    ds_read_b64_tr_b16 v[100:101], v19 offset:0
    ds_read_b64_tr_b16 v[102:103], v19 offset:4096
    v_max3_f32 v150, v104, v105, v106
    v_max3_f32 v186, v107, v108, v109
    v_max3_f32 v150, v150, v110, v111
    v_max3_f32 v150, v150, v186, v148
    v_mov_b32 v151, v150
    s_nop 1
    v_permlane32_swap_b32 v150, v151
    s_nop 1
    v_max_f32 v150, v150, v151
    v_mov_b32 v151, v150
    s_nop 1
    v_permlane16_swap_b32 v150, v151
    s_nop 1
    v_max_f32 v150, v150, v151
    v_cmp_neq_f32 vcc, v150, v148
    v_mul_f32 v187, s72, v150
    s_cbranch_vccz L_sk3
    v_sub_f32 v186, v148, v150
    v_mul_f32 v186, s72, v186
    v_exp_f32 v186, v186
    v_mov_b32 v148, v150
    v_mul_f32 v149, v149, v186
    v_mul_f32 v116, v116, v186
    v_mul_f32 v117, v117, v186
    v_mul_f32 v118, v118, v186
    v_mul_f32 v119, v119, v186
    v_mul_f32 v120, v120, v186
    v_mul_f32 v121, v121, v186
    v_mul_f32 v122, v122, v186
    v_mul_f32 v123, v123, v186
    v_mul_f32 v124, v124, v186
    v_mul_f32 v125, v125, v186
    v_mul_f32 v126, v126, v186
    v_mul_f32 v127, v127, v186
    v_mul_f32 v128, v128, v186
    v_mul_f32 v129, v129, v186
    v_mul_f32 v130, v130, v186
    v_mul_f32 v131, v131, v186
    v_mul_f32 v132, v132, v186
    v_mul_f32 v133, v133, v186
    v_mul_f32 v134, v134, v186
    v_mul_f32 v135, v135, v186
    v_mul_f32 v136, v136, v186
    v_mul_f32 v137, v137, v186
    v_mul_f32 v138, v138, v186
    v_mul_f32 v139, v139, v186
    v_mul_f32 v140, v140, v186
    v_mul_f32 v141, v141, v186
    v_mul_f32 v142, v142, v186
    v_mul_f32 v143, v143, v186
    v_mul_f32 v144, v144, v186
    v_mul_f32 v145, v145, v186
    v_mul_f32 v146, v146, v186
    v_mul_f32 v147, v147, v186
L_sk3:
    v_fma_f32 v104, v104, s72, -v187
    v_fma_f32 v105, v105, s72, -v187
    v_fma_f32 v106, v106, s72, -v187
    v_fma_f32 v107, v107, s72, -v187
    v_fma_f32 v108, v108, s72, -v187
    v_fma_f32 v109, v109, s72, -v187
    v_fma_f32 v110, v110, s72, -v187
    v_fma_f32 v111, v111, s72, -v187
    v_exp_f32 v104, v104
    v_exp_f32 v105, v105
    v_exp_f32 v106, v106
    v_exp_f32 v107, v107
    v_exp_f32 v108, v108
    v_exp_f32 v109, v109
    v_exp_f32 v110, v110
    v_exp_f32 v111, v111
    v_add_f32 v150, v104, v105
    v_add_f32 v186, v106, v107
    v_cvt_pk_bf16_f32 v112, v104, v105
    v_cvt_pk_bf16_f32 v113, v106, v107
    v_cvt_pk_bf16_f32 v114, v108, v109
    v_cvt_pk_bf16_f32 v115, v110, v111
    v_add_f32 v150, v150, v108
    v_add_f32 v186, v186, v109
    v_add_f32 v150, v150, v110
    v_add_f32 v186, v186, v111
    v_add_f32 v149, v149, v150
    v_add_f32 v149, v149, v186
    s_waitcnt lgkmcnt(0)
    s_mov_b32 s24, s58
    s_mov_b32 s25, s59
    s_mov_b32 s26, 0x800000
    s_add_u32 m0, s21, 8192
    s_add_u32 s19, s18, 0
    buffer_load_dwordx4 v6, s[24:27], s19 offen nt lds
    s_add_u32 m0, s21, 9216
    s_add_u32 s19, s18, 8192
    buffer_load_dwordx4 v7, s[24:27], s19 offen nt lds
    s_add_u32 m0, s21, 10240
    s_add_u32 s19, s18, 16384
    buffer_load_dwordx4 v6, s[24:27], s19 offen nt lds
    s_add_u32 m0, s21, 11264
    s_add_u32 s19, s18, 24576
    buffer_load_dwordx4 v7, s[24:27], s19 offen nt lds
    s_add_u32 m0, s21, 12288
    s_add_u32 s19, s18, 32768
    buffer_load_dwordx4 v6, s[24:27], s19 offen nt lds
    s_add_u32 m0, s21, 13312
    s_add_u32 s19, s18, 40960
    buffer_load_dwordx4 v7, s[24:27], s19 offen nt lds
    s_add_u32 m0, s21, 14336
    s_add_u32 s19, s18, 49152
    buffer_load_dwordx4 v6, s[24:27], s19 offen nt lds
    s_add_u32 m0, s21, 15360
    s_add_u32 s19, s18, 57344
    buffer_load_dwordx4 v7, s[24:27], s19 offen nt lds
    v_mfma_f32_16x16x32_bf16 v[116:119], v[72:75], v[112:115], v[116:119]
    v_mfma_f32_16x16x32_bf16 v[120:123], v[76:79], v[112:115], v[120:123]
    v_mfma_f32_16x16x32_bf16 v[124:127], v[80:83], v[112:115], v[124:127]
    v_mfma_f32_16x16x32_bf16 v[128:131], v[84:87], v[112:115], v[128:131]
    v_mfma_f32_16x16x32_bf16 v[132:135], v[88:91], v[112:115], v[132:135]
    v_mfma_f32_16x16x32_bf16 v[136:139], v[92:95], v[112:115], v[136:139]
    v_mfma_f32_16x16x32_bf16 v[140:143], v[96:99], v[112:115], v[140:143]
    v_mfma_f32_16x16x32_bf16 v[144:147], v[100:103], v[112:115], v[144:147]
    s_waitcnt vmcnt(24)
    ds_read_b128 v[40:43], v8 offset:16384
    ds_read_b128 v[44:47], v9 offset:16384
    ds_read_b128 v[48:51], v10 offset:16384
    ds_read_b128 v[52:55], v11 offset:16384
    ds_read_b128 v[56:59], v8 offset:20480
    ds_read_b128 v[60:63], v9 offset:20480
    ds_read_b128 v[64:67], v10 offset:20480
    ds_read_b128 v[68:71], v11 offset:20480
    s_waitcnt lgkmcnt(0)
    v_mfma_f32_16x16x32_bf16 v[104:107], v[40:43], v[24:27], 0
    v_mfma_f32_16x16x32_bf16 v[108:111], v[56:59], v[24:27], 0
    v_mfma_f32_16x16x32_bf16 v[104:107], v[44:47], v[28:31], v[104:107]
    v_mfma_f32_16x16x32_bf16 v[108:111], v[60:63], v[28:31], v[108:111]
    v_mfma_f32_16x16x32_bf16 v[104:107], v[48:51], v[32:35], v[104:107]
    v_mfma_f32_16x16x32_bf16 v[108:111], v[64:67], v[32:35], v[108:111]
    v_mfma_f32_16x16x32_bf16 v[104:107], v[52:55], v[36:39], v[104:107]
    v_mfma_f32_16x16x32_bf16 v[108:111], v[68:71], v[36:39], v[108:111]
    s_waitcnt vmcnt(16)
    ds_read_b64_tr_b16 v[72:73], v12 offset:16384
    ds_read_b64_tr_b16 v[74:75], v12 offset:20480
    ds_read_b64_tr_b16 v[76:77], v13 offset:16384
    ds_read_b64_tr_b16 v[78:79], v13 offset:20480
    ds_read_b64_tr_b16 v[80:81], v14 offset:16384
    ds_read_b64_tr_b16 v[82:83], v14 offset:20480
    ds_read_b64_tr_b16 v[84:85], v15 offset:16384
    ds_read_b64_tr_b16 v[86:87], v15 offset:20480
    ds_read_b64_tr_b16 v[88:89], v16 offset:16384
    ds_read_b64_tr_b16 v[90:91], v16 offset:20480
    ds_read_b64_tr_b16 v[92:93], v17 offset:16384
    ds_read_b64_tr_b16 v[94:95], v17 offset:20480
    ds_read_b64_tr_b16 v[96:97], v18 offset:16384
    ds_read_b64_tr_b16 v[98:99], v18 offset:20480
    ds_read_b64_tr_b16 v[100:101], v19 offset:16384
    ds_read_b64_tr_b16 v[102:103], v19 offset:20480
    v_max3_f32 v150, v104, v105, v106
    v_max3_f32 v186, v107, v108, v109
    v_max3_f32 v150, v150, v110, v111
    v_max3_f32 v150, v150, v186, v148
    v_mov_b32 v151, v150
    s_nop 1
    v_permlane32_swap_b32 v150, v151
    s_nop 1
    v_max_f32 v150, v150, v151
    v_mov_b32 v151, v150
    s_nop 1
    v_permlane16_swap_b32 v150, v151
    s_nop 1
    v_max_f32 v150, v150, v151
    v_cmp_neq_f32 vcc, v150, v148
    v_mul_f32 v187, s72, v150
    s_cbranch_vccz L_sk4
    v_sub_f32 v186, v148, v150
    v_mul_f32 v186, s72, v186
    v_exp_f32 v186, v186
    v_mov_b32 v148, v150
    v_mul_f32 v149, v149, v186
    v_mul_f32 v116, v116, v186
    v_mul_f32 v117, v117, v186
    v_mul_f32 v118, v118, v186
    v_mul_f32 v119, v119, v186
    v_mul_f32 v120, v120, v186
    v_mul_f32 v121, v121, v186
    v_mul_f32 v122, v122, v186
    v_mul_f32 v123, v123, v186
    v_mul_f32 v124, v124, v186
    v_mul_f32 v125, v125, v186
    v_mul_f32 v126, v126, v186
    v_mul_f32 v127, v127, v186
    v_mul_f32 v128, v128, v186
    v_mul_f32 v129, v129, v186
    v_mul_f32 v130, v130, v186
    v_mul_f32 v131, v131, v186
    v_mul_f32 v132, v132, v186
    v_mul_f32 v133, v133, v186
    v_mul_f32 v134, v134, v186
    v_mul_f32 v135, v135, v186
    v_mul_f32 v136, v136, v186
    v_mul_f32 v137, v137, v186
    v_mul_f32 v138, v138, v186
    v_mul_f32 v139, v139, v186
    v_mul_f32 v140, v140, v186
    v_mul_f32 v141, v141, v186
    v_mul_f32 v142, v142, v186
    v_mul_f32 v143, v143, v186
    v_mul_f32 v144, v144, v186
    v_mul_f32 v145, v145, v186
    v_mul_f32 v146, v146, v186
    v_mul_f32 v147, v147, v186
L_sk4:
    v_fma_f32 v104, v104, s72, -v187
    v_fma_f32 v105, v105, s72, -v187
    v_fma_f32 v106, v106, s72, -v187
    v_fma_f32 v107, v107, s72, -v187
    v_fma_f32 v108, v108, s72, -v187
    v_fma_f32 v109, v109, s72, -v187
    v_fma_f32 v110, v110, s72, -v187
    v_fma_f32 v111, v111, s72, -v187
    v_exp_f32 v104, v104
    v_exp_f32 v105, v105
    v_exp_f32 v106, v106
    v_exp_f32 v107, v107
    v_exp_f32 v108, v108
    v_exp_f32 v109, v109
    v_exp_f32 v110, v110
    v_exp_f32 v111, v111
    v_add_f32 v150, v104, v105
    v_add_f32 v186, v106, v107
    v_cvt_pk_bf16_f32 v112, v104, v105
    v_cvt_pk_bf16_f32 v113, v106, v107
    v_cvt_pk_bf16_f32 v114, v108, v109
    v_cvt_pk_bf16_f32 v115, v110, v111
    v_add_f32 v150, v150, v108
    v_add_f32 v186, v186, v109
    v_add_f32 v150, v150, v110
    v_add_f32 v186, v186, v111
    v_add_f32 v149, v149, v150
    v_add_f32 v149, v149, v186
    s_waitcnt lgkmcnt(0)
    v_mfma_f32_16x16x32_bf16 v[116:119], v[72:75], v[112:115], v[116:119]
    v_mfma_f32_16x16x32_bf16 v[120:123], v[76:79], v[112:115], v[120:123]
    v_mfma_f32_16x16x32_bf16 v[124:127], v[80:83], v[112:115], v[124:127]
    v_mfma_f32_16x16x32_bf16 v[128:131], v[84:87], v[112:115], v[128:131]
    v_mfma_f32_16x16x32_bf16 v[132:135], v[88:91], v[112:115], v[132:135]
    v_mfma_f32_16x16x32_bf16 v[136:139], v[92:95], v[112:115], v[136:139]
    v_mfma_f32_16x16x32_bf16 v[140:143], v[96:99], v[112:115], v[140:143]
    v_mfma_f32_16x16x32_bf16 v[144:147], v[100:103], v[112:115], v[144:147]
    v_mov_b32 v151, v149
    s_nop 1
    v_permlane32_swap_b32 v149, v151
    s_nop 1
    v_add_f32 v149, v149, v151
    v_mov_b32 v151, v149
    s_nop 1
    v_permlane16_swap_b32 v149, v151
    s_nop 1
    v_add_f32 v149, v149, v151
    s_mul_i32 s19, s3, 544
    s_add_u32 s19, s19, 147712
    v_add_u32 v22, s19, v20
    v_mov_b32 v23, s19
    v_cmp_eq_u32 vcc, 0, v2
    s_nop 4
    s_and_saveexec_b64 s[68:69], vcc
    ds_write_b128 v22, v[116:119] offset:0
    ds_write_b128 v22, v[120:123] offset:64
    ds_write_b128 v22, v[124:127] offset:128
    ds_write_b128 v22, v[128:131] offset:192
    ds_write_b128 v22, v[132:135] offset:256
    ds_write_b128 v22, v[136:139] offset:320
    ds_write_b128 v22, v[140:143] offset:384
    ds_write_b128 v22, v[144:147] offset:448
    ds_write_b64 v23, v[148:149] offset:512
    s_mov_b64 exec, s[68:69]
    s_waitcnt lgkmcnt(0)
    s_barrier
    v_lshrrev_b32 v22, 2, v2
    v_lshl_add_u32 v23, v1, 3, v22
    v_lshlrev_b32 v23, 8, v23
    v_and_b32 v32, 3, v0
    v_lshl_add_u32 v23, v32, 3, v23
    s_lshl_b32 s19, s3, 1
    v_xor_b32 v22, s19, v22
    v_lshl_add_u32 v24, v22, 5, v23
    v_xor_b32 v25, 0x80, v24
    v_add_u32 v25, 1024, v25
    v_xor_b32 v26, 32, v24
    v_xor_b32 v27, 32, v25
    v_add_u32 v28, 0x10000, v24
    v_add_u32 v29, 0x10000, v25
    v_add_u32 v30, 0x10000, v26
    v_add_u32 v31, 0x10000, v27
    v_add_u32 v32, 152192, v21
    v_and_b32 v33, 7, v0
    v_lshlrev_b32 v33, 3, v33
    v_add_u32 v33, 156288, v33
    s_lshl_b32 s19, s4, 5
    s_add_u32 s19, s19, s3
    s_lshl_b32 s19, s19, 5
    s_add_u32 s19, s19, s5
    s_lshl_b32 s19, s19, 7
    s_add_u32 s19, s19, 7340032
    v_lshlrev_b32 v34, 14, v2
    v_add3_u32 v34, v34, v20, s19
    s_waitcnt vmcnt(0)
    s_barrier
    ds_read_b64_tr_b16 v[40:41], v24 offset:0
    ds_read_b64_tr_b16 v[42:43], v25 offset:0
    ds_read_b64_tr_b16 v[44:45], v24 offset:32768
    ds_read_b64_tr_b16 v[46:47], v25 offset:32768
    ds_read_b64_tr_b16 v[48:49], v28 offset:0
    ds_read_b64_tr_b16 v[50:51], v29 offset:0
    ds_read_b64_tr_b16 v[52:53], v28 offset:32768
    ds_read_b64_tr_b16 v[54:55], v29 offset:32768
    ds_read_b64_tr_b16 v[56:57], v26 offset:0
    ds_read_b64_tr_b16 v[58:59], v27 offset:0
    ds_read_b64_tr_b16 v[60:61], v26 offset:32768
    ds_read_b64_tr_b16 v[62:63], v27 offset:32768
    ds_read_b64_tr_b16 v[64:65], v30 offset:0
    ds_read_b64_tr_b16 v[66:67], v31 offset:0
    ds_read_b64_tr_b16 v[68:69], v30 offset:32768
    ds_read_b64_tr_b16 v[70:71], v31 offset:32768
    ds_read_b64_tr_b16 v[72:73], v24 offset:8192
    ds_read_b64_tr_b16 v[74:75], v25 offset:8192
    ds_read_b64_tr_b16 v[76:77], v24 offset:40960
    ds_read_b64_tr_b16 v[78:79], v25 offset:40960
    ds_read_b64_tr_b16 v[80:81], v28 offset:8192
    ds_read_b64_tr_b16 v[82:83], v29 offset:8192
    ds_read_b64_tr_b16 v[84:85], v28 offset:40960
    ds_read_b64_tr_b16 v[86:87], v29 offset:40960
    ds_read_b64_tr_b16 v[88:89], v26 offset:8192
    ds_read_b64_tr_b16 v[90:91], v27 offset:8192
    ds_read_b64_tr_b16 v[92:93], v26 offset:40960
    ds_read_b64_tr_b16 v[94:95], v27 offset:40960
    ds_read_b64_tr_b16 v[96:97], v30 offset:8192
    ds_read_b64_tr_b16 v[98:99], v31 offset:8192
    ds_read_b64_tr_b16 v[100:101], v30 offset:40960
    ds_read_b64_tr_b16 v[102:103], v31 offset:40960
    ds_read_b128 v[132:135], v32 offset:2048
    ds_read_b128 v[136:139], v32 offset:2112
    ds_read_b128 v[140:143], v32 offset:2176
    ds_read_b128 v[144:147], v32 offset:2240
    ds_read_b64 v[36:37], v33
    s_waitcnt lgkmcnt(0)
    v_mfma_f32_16x16x32_bf16 v[160:163], v[72:75], v[132:135], 0
    v_mfma_f32_16x16x32_bf16 v[164:167], v[88:91], v[132:135], 0
    v_mfma_f32_16x16x32_bf16 v[160:163], v[76:79], v[136:139], v[160:163]
    v_mfma_f32_16x16x32_bf16 v[164:167], v[92:95], v[136:139], v[164:167]
    v_mfma_f32_16x16x32_bf16 v[160:163], v[80:83], v[140:143], v[160:163]
    v_mfma_f32_16x16x32_bf16 v[164:167], v[96:99], v[140:143], v[164:167]
    v_mfma_f32_16x16x32_bf16 v[160:163], v[84:87], v[144:147], v[160:163]
    v_mfma_f32_16x16x32_bf16 v[164:167], v[100:103], v[144:147], v[164:167]
    s_barrier
    ds_read_b128 v[116:119], v32 offset:0
    ds_read_b128 v[120:123], v32 offset:64
    ds_read_b128 v[124:127], v32 offset:128
    ds_read_b128 v[128:131], v32 offset:192
    v_mul_f32 v160, v37, v160
    v_mul_f32 v161, v37, v161
    v_mul_f32 v162, v37, v162
    v_mul_f32 v163, v37, v163
    v_mul_f32 v164, v37, v164
    v_mul_f32 v165, v37, v165
    v_mul_f32 v166, v37, v166
    v_mul_f32 v167, v37, v167
    v_cmp_gt_u32 vcc, 8, v2
    s_waitcnt lgkmcnt(0)
    v_mfma_f32_16x16x32_bf16 v[152:155], v[40:43], v[116:119], 0
    v_mfma_f32_16x16x32_bf16 v[156:159], v[56:59], v[116:119], 0
    v_mfma_f32_16x16x32_bf16 v[152:155], v[44:47], v[120:123], v[152:155]
    v_mfma_f32_16x16x32_bf16 v[156:159], v[60:63], v[120:123], v[156:159]
    v_mfma_f32_16x16x32_bf16 v[152:155], v[48:51], v[124:127], v[152:155]
    v_mfma_f32_16x16x32_bf16 v[156:159], v[64:67], v[124:127], v[156:159]
    v_mfma_f32_16x16x32_bf16 v[152:155], v[52:55], v[128:131], v[152:155]
    v_mfma_f32_16x16x32_bf16 v[156:159], v[68:71], v[128:131], v[156:159]
    s_and_saveexec_b64 s[68:69], vcc
    s_nop 7
    v_fma_f32 v160, v36, v152, v160
    v_fma_f32 v161, v36, v153, v161
    v_fma_f32 v162, v36, v154, v162
    v_fma_f32 v163, v36, v155, v163
    v_fma_f32 v164, v36, v156, v164
    v_fma_f32 v165, v36, v157, v165
    v_fma_f32 v166, v36, v158, v166
    v_fma_f32 v167, v36, v159, v167
    v_min_u32 v160, -2, v160
    v_min_u32 v161, -2, v161
    v_min_u32 v162, -2, v162
    v_min_u32 v163, -2, v163
    v_min_u32 v164, -2, v164
    v_min_u32 v165, -2, v165
    v_min_u32 v166, -2, v166
    v_min_u32 v167, -2, v167
    global_store_dwordx4 v34, v[160:163], s[66:67] sc1
    global_store_dwordx4 v34, v[164:167], s[66:67] offset:64 sc1
    s_endpgm
L_evIB:
    s_mov_b32 s18, s16
    s_mov_b32 s16, s22
    s_add_u32 s17, s16, 16384
    s_mov_b32 s8, s52
    s_mov_b32 s9, s53
    s_mov_b32 s10, 0x2000000
    s_mov_b32 s12, s54
    s_mov_b32 s13, s55
    s_mov_b32 s14, 0x2000000
    s_branch L_rIB
L_evIA:
    s_mov_b32 s16, s18
    s_add_u32 s17, s16, 16384
    s_mov_b32 s8, s42
    s_mov_b32 s9, s43
    s_mov_b32 s10, 0x10000000
    s_mov_b32 s12, s44
    s_mov_b32 s13, s45
    s_mov_b32 s14, 0x10000000
    s_branch L_rIA
L_evB0:
    s_barrier
    ds_read_b128 v[24:27], v23 offset:0
    ds_read_b128 v[28:31], v23 offset:64
    ds_read_b128 v[32:35], v23 offset:128
    ds_read_b128 v[36:39], v23 offset:192
    s_nop 7
    v_mov_b32 v152, v116
    v_mov_b32 v153, v117
    v_mov_b32 v154, v118
    v_mov_b32 v155, v119
    v_mov_b32 v156, v120
    v_mov_b32 v157, v121
    v_mov_b32 v158, v122
    v_mov_b32 v159, v123
    v_mov_b32 v160, v124
    v_mov_b32 v161, v125
    v_mov_b32 v162, v126
    v_mov_b32 v163, v127
    v_mov_b32 v164, v128
    v_mov_b32 v165, v129
    v_mov_b32 v166, v130
    v_mov_b32 v167, v131
    v_mov_b32 v168, v132
    v_mov_b32 v169, v133
    v_mov_b32 v170, v134
    v_mov_b32 v171, v135
    v_mov_b32 v172, v136
    v_mov_b32 v173, v137
    v_mov_b32 v174, v138
    v_mov_b32 v175, v139
    v_mov_b32 v176, v140
    v_mov_b32 v177, v141
    v_mov_b32 v178, v142
    v_mov_b32 v179, v143
    v_mov_b32 v180, v144
    v_mov_b32 v181, v145
    v_mov_b32 v182, v146
    v_mov_b32 v183, v147
    v_mov_b32 v184, v148
    v_mov_b32 v185, v149
    v_mov_b32 v116, 0
    v_mov_b32 v117, 0
    v_mov_b32 v118, 0
    v_mov_b32 v119, 0
    v_mov_b32 v120, 0
    v_mov_b32 v121, 0
    v_mov_b32 v122, 0
    v_mov_b32 v123, 0
    v_mov_b32 v124, 0
    v_mov_b32 v125, 0
    v_mov_b32 v126, 0
    v_mov_b32 v127, 0
    v_mov_b32 v128, 0
    v_mov_b32 v129, 0
    v_mov_b32 v130, 0
    v_mov_b32 v131, 0
    v_mov_b32 v132, 0
    v_mov_b32 v133, 0
    v_mov_b32 v134, 0
    v_mov_b32 v135, 0
    v_mov_b32 v136, 0
    v_mov_b32 v137, 0
    v_mov_b32 v138, 0
    v_mov_b32 v139, 0
    v_mov_b32 v140, 0
    v_mov_b32 v141, 0
    v_mov_b32 v142, 0
    v_mov_b32 v143, 0
    v_mov_b32 v144, 0
    v_mov_b32 v145, 0
    v_mov_b32 v146, 0
    v_mov_b32 v147, 0
    v_mov_b32 v148, 0xff7fffff
    v_mov_b32 v149, 0
    s_branch L_rB0
L_evB1:
    v_mov_b32 v151, v149
    s_nop 1
    v_permlane32_swap_b32 v149, v151
    s_nop 1
    v_add_f32 v149, v149, v151
    v_mov_b32 v151, v149
    s_nop 1
    v_permlane16_swap_b32 v149, v151
    s_nop 1
    v_add_f32 v149, v149, v151
    s_lshl_b32 s19, s3, 12
    s_add_u32 s19, s19, 131072
    v_lshl_add_u32 v150, v2, 9, v20
    v_add_u32 v150, s19, v150
    s_lshl_b32 s19, s3, 6
    s_add_u32 s19, s19, 147456
    v_lshlrev_b32 v151, 3, v2
    v_add_u32 v151, s19, v151
    v_cmp_gt_u32 vcc, 8, v2
    s_and_saveexec_b64 s[68:69], vcc
    ds_write_b128 v150, v[116:119] offset:0
    ds_write_b128 v150, v[120:123] offset:64
    ds_write_b128 v150, v[124:127] offset:128
    ds_write_b128 v150, v[128:131] offset:192
    ds_write_b128 v150, v[132:135] offset:256
    ds_write_b128 v150, v[136:139] offset:320
    ds_write_b128 v150, v[140:143] offset:384
    ds_write_b128 v150, v[144:147] offset:448
    ds_write_b64 v151, v[148:149]
    s_mov_b64 exec, s[68:69]
    ds_read_b128 v[24:27], v22 offset:0
    ds_read_b128 v[28:31], v22 offset:64
    ds_read_b128 v[32:35], v22 offset:128
    ds_read_b128 v[36:39], v22 offset:192
    s_waitcnt lgkmcnt(0)
    s_barrier
    v_mov_b32 v116, v152
    v_mov_b32 v117, v153
    v_mov_b32 v118, v154
    v_mov_b32 v119, v155
    v_mov_b32 v120, v156
    v_mov_b32 v121, v157
    v_mov_b32 v122, v158
    v_mov_b32 v123, v159
    v_mov_b32 v124, v160
    v_mov_b32 v125, v161
    v_mov_b32 v126, v162
    v_mov_b32 v127, v163
    v_mov_b32 v128, v164
    v_mov_b32 v129, v165
    v_mov_b32 v130, v166
    v_mov_b32 v131, v167
    v_mov_b32 v132, v168
    v_mov_b32 v133, v169
    v_mov_b32 v134, v170
    v_mov_b32 v135, v171
    v_mov_b32 v136, v172
    v_mov_b32 v137, v173
    v_mov_b32 v138, v174
    v_mov_b32 v139, v175
    v_mov_b32 v140, v176
    v_mov_b32 v141, v177
    v_mov_b32 v142, v178
    v_mov_b32 v143, v179
    v_mov_b32 v144, v180
    v_mov_b32 v145, v181
    v_mov_b32 v146, v182
    v_mov_b32 v147, v183
    v_mov_b32 v148, v184
    v_mov_b32 v149, v185
    s_branch L_rB1
L_ctrl:
    s_setprio 3
    s_sub_u32 s3, s3, 4
    v_lshlrev_b32 v4, 16, v1
    v_lshl_add_u32 v4, v2, 4, v4
    v_lshrrev_b32 v5, 3, v2
    v_lshlrev_b32 v5, 11, v5
    v_lshl_add_u32 v5, v1, 4, v5
    s_lshl_b32 s18, s4, 20
    s_lshl_b32 s19, s3, 18
    s_add_u32 s18, s18, s19
    s_lshl_b32 s19, s5, 8
    s_add_u32 s18, s18, s19
    s_lshl_b32 s16, s4, 8
    s_lshl_b32 s19, s3, 6
    s_add_u32 s16, s16, s19
    s_waitcnt lgkmcnt(0)
    s_mov_b32 s24, s46
    s_mov_b32 s25, s47
    s_mov_b32 s26, 0x800000
    s_mov_b32 s32, s40
    s_mov_b32 s33, s41
    s_mov_b32 s34, 16384
    v_mov_b32 v9, 0xf0000
    s_movk_i32 s28, 0xff
    global_load_dword v9, v9, s[66:67] sc1
    s_add_u32 s19, s16, 0
    buffer_load_dwordx4 v[24:27], v5, s[32:35], s19 offen
    s_add_u32 s19, s16, 4096
    buffer_load_dwordx4 v[28:31], v5, s[32:35], s19 offen
    s_add_u32 s19, s16, 8192
    buffer_load_dwordx4 v[32:35], v5, s[32:35], s19 offen
    s_add_u32 s19, s16, 12288
    buffer_load_dwordx4 v[36:39], v5, s[32:35], s19 offen
    s_add_u32 s19, s18, 0
    buffer_load_dwordx4 v[192:195], v4, s[24:27], s19 offen nt
    s_add_u32 s19, s18, 8192
    buffer_load_dwordx4 v[196:199], v4, s[24:27], s19 offen nt
    s_add_u32 s19, s18, 16384
    buffer_load_dwordx4 v[200:203], v4, s[24:27], s19 offen nt
    s_add_u32 s19, s18, 24576
    buffer_load_dwordx4 v[204:207], v4, s[24:27], s19 offen nt
    s_add_u32 s19, s18, 32768
    buffer_load_dwordx4 v[208:211], v4, s[24:27], s19 offen nt
    s_add_u32 s19, s18, 40960
    buffer_load_dwordx4 v[212:215], v4, s[24:27], s19 offen nt
    s_add_u32 s19, s18, 49152
    buffer_load_dwordx4 v[216:219], v4, s[24:27], s19 offen nt
    s_add_u32 s19, s18, 57344
    buffer_load_dwordx4 v[220:223], v4, s[24:27], s19 offen nt
    v_and_b32 v48, 1, v2
    v_cmp_eq_u32 vcc, 1, v48
    v_bfe_u32 v49, v2, 1, 2
    v_mov_b32 v50, 0xc0c0100
    v_mov_b32 v51, 0x1000c0c
    v_cndmask_b32 v52, v50, v51, vcc
    v_mov_b32 v50, 0xc0c0302
    v_mov_b32 v51, 0x3020c0c
    v_cndmask_b32 v53, v50, v51, vcc
    v_mov_b32 v50, 0x0c0c0c0c
    v_cmp_eq_u32 vcc, 0, v49
    v_cndmask_b32 v40, v50, v52, vcc
    v_cndmask_b32 v44, v50, v53, vcc
    v_cmp_eq_u32 vcc, 1, v49
    v_cndmask_b32 v41, v50, v52, vcc
    v_cndmask_b32 v45, v50, v53, vcc
    v_cmp_eq_u32 vcc, 2, v49
    v_cndmask_b32 v42, v50, v52, vcc
    v_cndmask_b32 v46, v50, v53, vcc
    v_cmp_eq_u32 vcc, 3, v49
    v_cndmask_b32 v43, v50, v52, vcc
    v_cndmask_b32 v47, v50, v53, vcc
    v_cmp_gt_u32 s[70:71], 8, v2
    v_cmp_gt_u32 s[74:75], 32, v0
    v_add_u32 v15, 156352, v7
    v_mov_b32 v16, 0
    s_mov_b64 exec, 0xffff
    ds_write_b32 v15, v16
    s_mov_b64 exec, -1
    s_waitcnt lgkmcnt(0)
    s_barrier
    s_lshl_b32 s19, s3, 12
    s_add_u32 s19, s19, 131072
    v_lshrrev_b32 v14, 1, v1
    v_lshlrev_b32 v14, 9, v14
    v_lshl_add_u32 v14, v2, 5, v14
    v_and_b32 v16, 1, v1
    v_lshl_add_u32 v14, v16, 4, v14
    v_add_u32 v14, s19, v14
    s_lshl_b32 s19, s3, 10
    s_add_u32 s19, s19, 131072
    v_add_u32 v13, s19, v6
    s_lshl_b32 s19, s3, 18
    s_lshl_b32 s17, s5, 12
    s_add_u32 s19, s19, s17
    s_lshl_b32 s17, s4, 9
    s_add_u32 s19, s19, s17
    v_lshrrev_b32 v12, 5, v0
    v_lshlrev_b32 v12, 17, v12
    v_and_b32 v16, 31, v0
    v_lshl_add_u32 v12, v16, 4, v12
    v_add_u32 v12, s19, v12
    s_lshl_b32 s19, s5, 2
    v_mov_b32 v11, s19
    s_waitcnt vmcnt(8)
    v_and_b32 v9, 0xff, v9
    v_add_u32 v10, 0xffffff02, v9
    v_min_u32 v9, v9, v10
    v_add_u32 v9, 1, v9
    s_nop 0
    v_readfirstlane_b32 s79, v9
    v_perm_b32 v64, v24, v24, v40
    v_perm_b32 v65, v24, v24, v41
    v_perm_b32 v66, v24, v24, v42
    v_perm_b32 v67, v24, v24, v43
    v_perm_b32 v68, v28, v28, v40
    v_perm_b32 v69, v28, v28, v41
    v_perm_b32 v70, v28, v28, v42
    v_perm_b32 v71, v28, v28, v43
    v_perm_b32 v72, v32, v32, v40
    v_perm_b32 v73, v32, v32, v41
    v_perm_b32 v74, v32, v32, v42
    v_perm_b32 v75, v32, v32, v43
    v_perm_b32 v76, v36, v36, v40
    v_perm_b32 v77, v36, v36, v41
    v_perm_b32 v78, v36, v36, v42
    v_perm_b32 v79, v36, v36, v43
    v_perm_b32 v80, v24, v24, v44
    v_perm_b32 v81, v24, v24, v45
    v_perm_b32 v82, v24, v24, v46
    v_perm_b32 v83, v24, v24, v47
    v_perm_b32 v84, v28, v28, v44
    v_perm_b32 v85, v28, v28, v45
    v_perm_b32 v86, v28, v28, v46
    v_perm_b32 v87, v28, v28, v47
    v_perm_b32 v88, v32, v32, v44
    v_perm_b32 v89, v32, v32, v45
    v_perm_b32 v90, v32, v32, v46
    v_perm_b32 v91, v32, v32, v47
    v_perm_b32 v92, v36, v36, v44
    v_perm_b32 v93, v36, v36, v45
    v_perm_b32 v94, v36, v36, v46
    v_perm_b32 v95, v36, v36, v47
    v_perm_b32 v96, v25, v25, v40
    v_perm_b32 v97, v25, v25, v41
    v_perm_b32 v98, v25, v25, v42
    v_perm_b32 v99, v25, v25, v43
    v_perm_b32 v100, v29, v29, v40
    v_perm_b32 v101, v29, v29, v41
    v_perm_b32 v102, v29, v29, v42
    v_perm_b32 v103, v29, v29, v43
    v_perm_b32 v104, v33, v33, v40
    v_perm_b32 v105, v33, v33, v41
    v_perm_b32 v106, v33, v33, v42
    v_perm_b32 v107, v33, v33, v43
    v_perm_b32 v108, v37, v37, v40
    v_perm_b32 v109, v37, v37, v41
    v_perm_b32 v110, v37, v37, v42
    v_perm_b32 v111, v37, v37, v43
    v_perm_b32 v112, v25, v25, v44
    v_perm_b32 v113, v25, v25, v45
    v_perm_b32 v114, v25, v25, v46
    v_perm_b32 v115, v25, v25, v47
    v_perm_b32 v116, v29, v29, v44
    v_perm_b32 v117, v29, v29, v45
    v_perm_b32 v118, v29, v29, v46
    v_perm_b32 v119, v29, v29, v47
    v_perm_b32 v120, v33, v33, v44
    v_perm_b32 v121, v33, v33, v45
    v_perm_b32 v122, v33, v33, v46
    v_perm_b32 v123, v33, v33, v47
    v_perm_b32 v124, v37, v37, v44
    v_perm_b32 v125, v37, v37, v45
    v_perm_b32 v126, v37, v37, v46
    v_perm_b32 v127, v37, v37, v47
    v_perm_b32 v128, v26, v26, v40
    v_perm_b32 v129, v26, v26, v41
    v_perm_b32 v130, v26, v26, v42
    v_perm_b32 v131, v26, v26, v43
    v_perm_b32 v132, v30, v30, v40
    v_perm_b32 v133, v30, v30, v41
    v_perm_b32 v134, v30, v30, v42
    v_perm_b32 v135, v30, v30, v43
    v_perm_b32 v136, v34, v34, v40
    v_perm_b32 v137, v34, v34, v41
    v_perm_b32 v138, v34, v34, v42
    v_perm_b32 v139, v34, v34, v43
    v_perm_b32 v140, v38, v38, v40
    v_perm_b32 v141, v38, v38, v41
    v_perm_b32 v142, v38, v38, v42
    v_perm_b32 v143, v38, v38, v43
    v_perm_b32 v144, v26, v26, v44
    v_perm_b32 v145, v26, v26, v45
    v_perm_b32 v146, v26, v26, v46
    v_perm_b32 v147, v26, v26, v47
    v_perm_b32 v148, v30, v30, v44
    v_perm_b32 v149, v30, v30, v45
    v_perm_b32 v150, v30, v30, v46
    v_perm_b32 v151, v30, v30, v47
    v_perm_b32 v152, v34, v34, v44
    v_perm_b32 v153, v34, v34, v45
    v_perm_b32 v154, v34, v34, v46
    v_perm_b32 v155, v34, v34, v47
    v_perm_b32 v156, v38, v38, v44
    v_perm_b32 v157, v38, v38, v45
    v_perm_b32 v158, v38, v38, v46
    v_perm_b32 v159, v38, v38, v47
    v_perm_b32 v160, v27, v27, v40
    v_perm_b32 v161, v27, v27, v41
    v_perm_b32 v162, v27, v27, v42
    v_perm_b32 v163, v27, v27, v43
    v_perm_b32 v164, v31, v31, v40
    v_perm_b32 v165, v31, v31, v41
    v_perm_b32 v166, v31, v31, v42
    v_perm_b32 v167, v31, v31, v43
    v_perm_b32 v168, v35, v35, v40
    v_perm_b32 v169, v35, v35, v41
    v_perm_b32 v170, v35, v35, v42
    v_perm_b32 v171, v35, v35, v43
    v_perm_b32 v172, v39, v39, v40
    v_perm_b32 v173, v39, v39, v41
    v_perm_b32 v174, v39, v39, v42
    v_perm_b32 v175, v39, v39, v43
    v_perm_b32 v176, v27, v27, v44
    v_perm_b32 v177, v27, v27, v45
    v_perm_b32 v178, v27, v27, v46
    v_perm_b32 v179, v27, v27, v47
    v_perm_b32 v180, v31, v31, v44
    v_perm_b32 v181, v31, v31, v45
    v_perm_b32 v182, v31, v31, v46
    v_perm_b32 v183, v31, v31, v47
    v_perm_b32 v184, v35, v35, v44
    v_perm_b32 v185, v35, v35, v45
    v_perm_b32 v186, v35, v35, v46
    v_perm_b32 v187, v35, v35, v47
    v_perm_b32 v188, v39, v39, v44
    v_perm_b32 v189, v39, v39, v45
    v_perm_b32 v190, v39, v39, v46
    v_perm_b32 v191, v39, v39, v47
    s_waitcnt vmcnt(7)
    v_mfma_f32_16x16x32_bf16 v[48:51], v[64:67], v[192:195], 0
    v_mfma_f32_16x16x32_bf16 v[52:55], v[68:71], v[192:195], 0
    v_mfma_f32_16x16x32_bf16 v[56:59], v[72:75], v[192:195], 0
    v_mfma_f32_16x16x32_bf16 v[60:63], v[76:79], v[192:195], 0
    s_waitcnt vmcnt(6)
    v_mfma_f32_16x16x32_bf16 v[48:51], v[80:83], v[196:199], v[48:51]
    v_mfma_f32_16x16x32_bf16 v[52:55], v[84:87], v[196:199], v[52:55]
    v_mfma_f32_16x16x32_bf16 v[56:59], v[88:91], v[196:199], v[56:59]
    v_mfma_f32_16x16x32_bf16 v[60:63], v[92:95], v[196:199], v[60:63]
    s_waitcnt vmcnt(5)
    v_mfma_f32_16x16x32_bf16 v[48:51], v[96:99], v[200:203], v[48:51]
    v_mfma_f32_16x16x32_bf16 v[52:55], v[100:103], v[200:203], v[52:55]
    v_mfma_f32_16x16x32_bf16 v[56:59], v[104:107], v[200:203], v[56:59]
    v_mfma_f32_16x16x32_bf16 v[60:63], v[108:111], v[200:203], v[60:63]
    s_waitcnt vmcnt(4)
    v_mfma_f32_16x16x32_bf16 v[48:51], v[112:115], v[204:207], v[48:51]
    v_mfma_f32_16x16x32_bf16 v[52:55], v[116:119], v[204:207], v[52:55]
    v_mfma_f32_16x16x32_bf16 v[56:59], v[120:123], v[204:207], v[56:59]
    v_mfma_f32_16x16x32_bf16 v[60:63], v[124:127], v[204:207], v[60:63]
    s_waitcnt vmcnt(3)
    v_mfma_f32_16x16x32_bf16 v[48:51], v[128:131], v[208:211], v[48:51]
    v_mfma_f32_16x16x32_bf16 v[52:55], v[132:135], v[208:211], v[52:55]
    v_mfma_f32_16x16x32_bf16 v[56:59], v[136:139], v[208:211], v[56:59]
    v_mfma_f32_16x16x32_bf16 v[60:63], v[140:143], v[208:211], v[60:63]
    s_waitcnt vmcnt(2)
    v_mfma_f32_16x16x32_bf16 v[48:51], v[144:147], v[212:215], v[48:51]
    v_mfma_f32_16x16x32_bf16 v[52:55], v[148:151], v[212:215], v[52:55]
    v_mfma_f32_16x16x32_bf16 v[56:59], v[152:155], v[212:215], v[56:59]
    v_mfma_f32_16x16x32_bf16 v[60:63], v[156:159], v[212:215], v[60:63]
    s_waitcnt vmcnt(1)
    v_mfma_f32_16x16x32_bf16 v[48:51], v[160:163], v[216:219], v[48:51]
    v_mfma_f32_16x16x32_bf16 v[52:55], v[164:167], v[216:219], v[52:55]
    v_mfma_f32_16x16x32_bf16 v[56:59], v[168:171], v[216:219], v[56:59]
    v_mfma_f32_16x16x32_bf16 v[60:63], v[172:175], v[216:219], v[60:63]
    s_waitcnt vmcnt(0)
    v_mfma_f32_16x16x32_bf16 v[48:51], v[176:179], v[220:223], v[48:51]
    v_mfma_f32_16x16x32_bf16 v[52:55], v[180:183], v[220:223], v[52:55]
    v_mfma_f32_16x16x32_bf16 v[56:59], v[184:187], v[220:223], v[56:59]
    v_mfma_f32_16x16x32_bf16 v[60:63], v[188:191], v[220:223], v[60:63]
    s_nop 7
    ds_write_b128 v14, v[48:51] offset:0
    ds_write_b128 v14, v[52:55] offset:1024
    ds_write_b128 v14, v[56:59] offset:2048
    ds_write_b128 v14, v[60:63] offset:3072
    s_waitcnt lgkmcnt(0)
    s_lshl_b32 s19, s3, 2
    s_add_u32 s19, s19, 156352
    v_mov_b32 v17, s19
    v_mov_b32 v16, 1
    ds_write_b32 v17, v16
    s_mov_b32 s77, 0x100000
L_fl5:
    ds_read_b32 v16, v15
    s_waitcnt lgkmcnt(0)
    v_cmp_eq_u32 vcc, 0, v16
    s_and_b32 s19, vcc_lo, 0xf
    s_cbranch_scc0 L_fd6
    s_sub_u32 s77, s77, 1
    s_cmp_lg_u32 s77, 0
    s_cbranch_scc1 L_fl5
L_fd6:
    ds_read_b128 v[48:51], v13 offset:0
    ds_read_b128 v[52:55], v13 offset:4096
    ds_read_b128 v[56:59], v13 offset:8192
    ds_read_b128 v[60:63], v13 offset:12288
    s_waitcnt lgkmcnt(0)
    v_add_f32 v48, v48, v52
    v_add_f32 v56, v56, v60
    v_add_f32 v49, v49, v53
    v_add_f32 v57, v57, v61
    v_add_f32 v50, v50, v54
    v_add_f32 v58, v58, v62
    v_add_f32 v51, v51, v55
    v_add_f32 v59, v59, v63
    v_add_f32 v48, v48, v56
    v_add_f32 v49, v49, v57
    v_add_f32 v50, v50, v58
    v_add_f32 v51, v51, v59
    v_min_u32 v48, -2, v48
    v_min_u32 v49, -2, v49
    v_min_u32 v50, -2, v50
    v_min_u32 v51, -2, v51
    v_bfi_b32 v48, s28, v9, v48
    v_bfi_b32 v49, s28, v9, v49
    v_bfi_b32 v50, s28, v9, v50
    v_bfi_b32 v51, s28, v9, v51
    v_add_u32 v16, 1048576, v12
    global_store_dwordx4 v16, v[48:51], s[66:67] sc1
    s_mov_b32 s24, s56
    s_mov_b32 s25, s57
    s_cmp_lg_u32 s3, 0
    s_cbranch_scc1 L_noq
    s_lshl_b32 s19, s78, 4
    s_add_u32 s19, s19, 1048576
    v_add_u32 v16, s19, v6
    v_and_b32 v17, 31, v0
    v_lshlrev_b32 v17, 3, v17
    v_add_u32 v17, 149888, v17
    s_mov_b32 s77, 0x8000
L_sp7:
    global_load_dwordx4 v[224:227], v16, s[66:67] offset:0 sc1
    global_load_dwordx4 v[228:231], v16, s[66:67] offset:1024 sc1
    global_load_dwordx4 v[232:235], v16, s[66:67] offset:2048 sc1
    global_load_dwordx4 v[236:239], v16, s[66:67] offset:3072 sc1
    s_waitcnt vmcnt(0)
    v_xor_b32 v18, v9, v239
    v_xor_b32 v19, v9, v238
    v_xor_b32 v20, v9, v237
    v_or3_b32 v18, v18, v19, v20
    v_xor_b32 v19, v9, v236
    v_xor_b32 v20, v9, v235
    v_or3_b32 v18, v18, v19, v20
    v_xor_b32 v19, v9, v234
    v_xor_b32 v20, v9, v233
    v_or3_b32 v18, v18, v19, v20
    v_xor_b32 v19, v9, v232
    v_xor_b32 v20, v9, v231
    v_or3_b32 v18, v18, v19, v20
    v_xor_b32 v19, v9, v230
    v_xor_b32 v20, v9, v229
    v_or3_b32 v18, v18, v19, v20
    v_xor_b32 v19, v9, v228
    v_xor_b32 v20, v9, v227
    v_or3_b32 v18, v18, v19, v20
    v_xor_b32 v19, v9, v226
    v_xor_b32 v20, v9, v225
    v_or3_b32 v18, v18, v19, v20
    v_xor_b32 v19, v9, v224
    v_or_b32 v18, v18, v19
    v_and_b32 v18, 0xff, v18
    v_cmp_ne_u32 vcc, 0, v18
    s_cbranch_vccz L_sd8
    s_sub_u32 s77, s77, 1
    s_cmp_lg_u32 s77, 0
    s_cbranch_scc1 L_sp7
L_sd8:
    v_add_f32 v224, v224, v228
    v_add_f32 v232, v232, v236
    v_add_f32 v225, v225, v229
    v_add_f32 v233, v233, v237
    v_add_f32 v226, v226, v230
    v_add_f32 v234, v234, v238
    v_add_f32 v227, v227, v231
    v_add_f32 v235, v235, v239
    v_add_f32 v224, v224, v232
    v_add_f32 v225, v225, v233
    v_add_f32 v226, v226, v234
    v_add_f32 v227, v227, v235
    v_mov_b32 v240, v224
    v_mov_b32 v241, v225
    v_mov_b32 v242, v226
    v_mov_b32 v243, v227
    s_nop 1
    v_permlane32_swap_b32 v224, v240
    v_permlane32_swap_b32 v225, v241
    v_permlane32_swap_b32 v226, v242
    v_permlane32_swap_b32 v227, v243
    s_nop 1
    v_add_f32 v224, v224, v240
    v_add_f32 v225, v225, v241
    v_add_f32 v226, v226, v242
    v_add_f32 v227, v227, v243
    v_cvt_pk_bf16_f32 v224, v224, v225
    v_cvt_pk_bf16_f32 v225, v226, v227
    ds_write_b64 v17, v[224:225]
L_ppj:
    s_waitcnt lgkmcnt(0)
    s_barrier
    s_add_u32 s19, s18, 0
    buffer_load_dwordx4 v[192:195], v4, s[24:27], s19 offen nt
    s_add_u32 s19, s18, 8192
    buffer_load_dwordx4 v[196:199], v4, s[24:27], s19 offen nt
    s_add_u32 s19, s18, 16384
    buffer_load_dwordx4 v[200:203], v4, s[24:27], s19 offen nt
    s_add_u32 s19, s18, 24576
    buffer_load_dwordx4 v[204:207], v4, s[24:27], s19 offen nt
    s_add_u32 s19, s18, 32768
    buffer_load_dwordx4 v[208:211], v4, s[24:27], s19 offen nt
    s_add_u32 s19, s18, 40960
    buffer_load_dwordx4 v[212:215], v4, s[24:27], s19 offen nt
    s_add_u32 s19, s18, 49152
    buffer_load_dwordx4 v[216:219], v4, s[24:27], s19 offen nt
    s_add_u32 s19, s18, 57344
    buffer_load_dwordx4 v[220:223], v4, s[24:27], s19 offen nt
    s_branch L_q2
L_noq:
    s_add_u32 s19, s18, 0
    buffer_load_dwordx4 v[192:195], v4, s[24:27], s19 offen nt
    s_add_u32 s19, s18, 8192
    buffer_load_dwordx4 v[196:199], v4, s[24:27], s19 offen nt
    s_add_u32 s19, s18, 16384
    buffer_load_dwordx4 v[200:203], v4, s[24:27], s19 offen nt
    s_add_u32 s19, s18, 24576
    buffer_load_dwordx4 v[204:207], v4, s[24:27], s19 offen nt
    s_add_u32 s19, s18, 32768
    buffer_load_dwordx4 v[208:211], v4, s[24:27], s19 offen nt
    s_add_u32 s19, s18, 40960
    buffer_load_dwordx4 v[212:215], v4, s[24:27], s19 offen nt
    s_add_u32 s19, s18, 49152
    buffer_load_dwordx4 v[216:219], v4, s[24:27], s19 offen nt
    s_add_u32 s19, s18, 57344
    buffer_load_dwordx4 v[220:223], v4, s[24:27], s19 offen nt
    s_barrier
L_q2:
    s_waitcnt vmcnt(7)
    v_mfma_f32_16x16x32_bf16 v[48:51], v[64:67], v[192:195], 0
    v_mfma_f32_16x16x32_bf16 v[52:55], v[68:71], v[192:195], 0
    v_mfma_f32_16x16x32_bf16 v[56:59], v[72:75], v[192:195], 0
    v_mfma_f32_16x16x32_bf16 v[60:63], v[76:79], v[192:195], 0
    s_waitcnt vmcnt(6)
    v_mfma_f32_16x16x32_bf16 v[48:51], v[80:83], v[196:199], v[48:51]
    v_mfma_f32_16x16x32_bf16 v[52:55], v[84:87], v[196:199], v[52:55]
    v_mfma_f32_16x16x32_bf16 v[56:59], v[88:91], v[196:199], v[56:59]
    v_mfma_f32_16x16x32_bf16 v[60:63], v[92:95], v[196:199], v[60:63]
    s_waitcnt vmcnt(5)
    v_mfma_f32_16x16x32_bf16 v[48:51], v[96:99], v[200:203], v[48:51]
    v_mfma_f32_16x16x32_bf16 v[52:55], v[100:103], v[200:203], v[52:55]
    v_mfma_f32_16x16x32_bf16 v[56:59], v[104:107], v[200:203], v[56:59]
    v_mfma_f32_16x16x32_bf16 v[60:63], v[108:111], v[200:203], v[60:63]
    s_waitcnt vmcnt(4)
    v_mfma_f32_16x16x32_bf16 v[48:51], v[112:115], v[204:207], v[48:51]
    v_mfma_f32_16x16x32_bf16 v[52:55], v[116:119], v[204:207], v[52:55]
    v_mfma_f32_16x16x32_bf16 v[56:59], v[120:123], v[204:207], v[56:59]
    v_mfma_f32_16x16x32_bf16 v[60:63], v[124:127], v[204:207], v[60:63]
    s_waitcnt vmcnt(3)
    v_mfma_f32_16x16x32_bf16 v[48:51], v[128:131], v[208:211], v[48:51]
    v_mfma_f32_16x16x32_bf16 v[52:55], v[132:135], v[208:211], v[52:55]
    v_mfma_f32_16x16x32_bf16 v[56:59], v[136:139], v[208:211], v[56:59]
    v_mfma_f32_16x16x32_bf16 v[60:63], v[140:143], v[208:211], v[60:63]
    s_waitcnt vmcnt(2)
    v_mfma_f32_16x16x32_bf16 v[48:51], v[144:147], v[212:215], v[48:51]
    v_mfma_f32_16x16x32_bf16 v[52:55], v[148:151], v[212:215], v[52:55]
    v_mfma_f32_16x16x32_bf16 v[56:59], v[152:155], v[212:215], v[56:59]
    v_mfma_f32_16x16x32_bf16 v[60:63], v[156:159], v[212:215], v[60:63]
    s_waitcnt vmcnt(1)
    v_mfma_f32_16x16x32_bf16 v[48:51], v[160:163], v[216:219], v[48:51]
    v_mfma_f32_16x16x32_bf16 v[52:55], v[164:167], v[216:219], v[52:55]
    v_mfma_f32_16x16x32_bf16 v[56:59], v[168:171], v[216:219], v[56:59]
    v_mfma_f32_16x16x32_bf16 v[60:63], v[172:175], v[216:219], v[60:63]
    s_waitcnt vmcnt(0)
    v_mfma_f32_16x16x32_bf16 v[48:51], v[176:179], v[220:223], v[48:51]
    v_mfma_f32_16x16x32_bf16 v[52:55], v[180:183], v[220:223], v[52:55]
    v_mfma_f32_16x16x32_bf16 v[56:59], v[184:187], v[220:223], v[56:59]
    v_mfma_f32_16x16x32_bf16 v[60:63], v[188:191], v[220:223], v[60:63]
    s_nop 7
    ds_write_b128 v14, v[48:51] offset:0
    ds_write_b128 v14, v[52:55] offset:1024
    ds_write_b128 v14, v[56:59] offset:2048
    ds_write_b128 v14, v[60:63] offset:3072
    s_waitcnt lgkmcnt(0)
    s_cmp_lg_u32 s3, 0
    s_cbranch_scc1 L_h4
    v_add_u32 v11, 917504, v6
    v_or_b32 v10, 0x5a5a5a00, v9
    s_mov_b32 s77, 0x8000
L_sp9:
    global_load_dwordx4 v[224:227], v11, s[66:67] offset:0 sc1
    global_load_dwordx4 v[228:231], v11, s[66:67] offset:1024 sc1
    s_waitcnt vmcnt(0)
    v_xor_b32 v18, v10, v231
    v_xor_b32 v19, v10, v230
    v_xor_b32 v20, v10, v229
    v_or3_b32 v18, v18, v19, v20
    v_xor_b32 v19, v10, v228
    v_xor_b32 v20, v10, v227
    v_or3_b32 v18, v18, v19, v20
    v_xor_b32 v19, v10, v226
    v_xor_b32 v20, v10, v225
    v_or3_b32 v18, v18, v19, v20
    v_xor_b32 v19, v10, v224
    v_or_b32 v18, v18, v19
    v_cmp_ne_u32 vcc, 0, v18
    s_cbranch_vccz L_sd10
    s_sub_u32 s77, s77, 1
    s_cmp_lg_u32 s77, 0
    s_cbranch_scc1 L_sp9
L_sd10:
L_h4:
    s_lshl_b32 s19, s3, 2
    s_add_u32 s19, s19, 156368
    v_mov_b32 v17, s19
    v_mov_b32 v16, 1
    ds_write_b32 v17, v16
    s_mov_b32 s77, 0x100000
L_fl11:
    ds_read_b32 v16, v15
    s_waitcnt lgkmcnt(0)
    v_cmp_eq_u32 vcc, 0, v16
    s_and_b32 s19, vcc_lo, 0xf0
    s_cbranch_scc0 L_fd12
    s_sub_u32 s77, s77, 1
    s_cmp_lg_u32 s77, 0
    s_cbranch_scc1 L_fl11
L_fd12:
    ds_read_b128 v[48:51], v13 offset:0
    ds_read_b128 v[52:55], v13 offset:4096
    ds_read_b128 v[56:59], v13 offset:8192
    ds_read_b128 v[60:63], v13 offset:12288
    s_waitcnt lgkmcnt(0)
    v_add_f32 v48, v48, v52
    v_add_f32 v56, v56, v60
    v_add_f32 v49, v49, v53
    v_add_f32 v57, v57, v61
    v_add_f32 v50, v50, v54
    v_add_f32 v58, v58, v62
    v_add_f32 v51, v51, v55
    v_add_f32 v59, v59, v63
    v_add_f32 v48, v48, v56
    v_add_f32 v49, v49, v57
    v_add_f32 v50, v50, v58
    v_add_f32 v51, v51, v59
    v_min_u32 v48, -2, v48
    v_min_u32 v49, -2, v49
    v_min_u32 v50, -2, v50
    v_min_u32 v51, -2, v51
    v_add_u32 v16, 2097152, v12
    global_store_dwordx4 v16, v[48:51], s[66:67] sc1
    s_cmp_eq_u32 s3, 0
    s_cbranch_scc1 L_main
    s_endpgm
L_main:
    v_mov_b32 v108, v6
    v_and_b32 v144, 31, v0
    v_lshlrev_b32 v144, 3, v144
    s_add_u32 s19, s76, 6291456
    v_add_u32 v150, s19, v7
    s_lshl_b32 s19, s78, 4
    s_add_u32 s19, s19, 7340032
    v_add_u32 v151, s19, v108
    s_lshl_b32 s19, s4, 11
    v_lshlrev_b32 v152, 5, v0
    v_add_u32 v153, s19, v152
    global_load_dwordx4 v[156:159], v153, s[40:41]
    global_load_dwordx4 v[160:163], v153, s[40:41] offset:16
    global_load_dwordx4 v[164:167], v152, s[60:61]
    global_load_dwordx4 v[168:171], v152, s[60:61] offset:16
    s_lshl_b32 s19, s78, 4
    s_add_u32 s19, s19, 2097152
    v_add_u32 v111, s19, v108
    s_mov_b32 s77, 0x8000
L_sp13:
    global_load_dwordx4 v[112:115], v111, s[66:67] offset:0 sc1
    global_load_dwordx4 v[116:119], v111, s[66:67] offset:1024 sc1
    global_load_dwordx4 v[120:123], v111, s[66:67] offset:2048 sc1
    global_load_dwordx4 v[124:127], v111, s[66:67] offset:3072 sc1
    s_waitcnt vmcnt(0)
    v_max3_u32 v110, v127, v126, v125
    v_max3_u32 v110, v110, v124, v123
    v_max3_u32 v110, v110, v122, v121
    v_max3_u32 v110, v110, v120, v119
    v_max3_u32 v110, v110, v118, v117
    v_max3_u32 v110, v110, v116, v115
    v_max3_u32 v110, v110, v114, v113
    v_max_u32 v110, v110, v112
    v_cmp_eq_u32 vcc, -1, v110
    s_cbranch_vccz L_sd14
    s_sub_u32 s77, s77, 1
    s_cmp_lg_u32 s77, 0
    s_cbranch_scc1 L_sp13
L_sd14:
    v_add_f32 v112, v112, v116
    v_add_f32 v120, v120, v124
    v_add_f32 v113, v113, v117
    v_add_f32 v121, v121, v125
    v_add_f32 v114, v114, v118
    v_add_f32 v122, v122, v126
    v_add_f32 v115, v115, v119
    v_add_f32 v123, v123, v127
    v_add_f32 v112, v112, v120
    v_add_f32 v113, v113, v121
    v_add_f32 v114, v114, v122
    v_add_f32 v115, v115, v123
    v_mov_b32 v128, v112
    v_mov_b32 v129, v113
    v_mov_b32 v130, v114
    v_mov_b32 v131, v115
    s_nop 1
    v_permlane32_swap_b32 v112, v128
    v_permlane32_swap_b32 v113, v129
    v_permlane32_swap_b32 v114, v130
    v_permlane32_swap_b32 v115, v131
    s_nop 1
    v_add_f32 v112, v112, v128
    v_add_f32 v113, v113, v129
    v_add_f32 v114, v114, v130
    v_add_f32 v115, v115, v131
    v_cvt_pk_bf16_f32 v112, v112, v113
    v_cvt_pk_bf16_f32 v113, v114, v115
    v_min_u32 v112, -2, v112
    v_min_u32 v113, -2, v113
    s_add_u32 s19, s78, 3145728
    v_add_u32 v16, s19, v144
    s_mov_b64 exec, s[74:75]
    global_store_dwordx2 v16, v[112:113], s[66:67] sc1
    s_mov_b64 exec, -1
    v_mov_b32 v154, 0
    v_lshlrev_b32 v172, 16, v156
    v_lshlrev_b32 v173, 16, v164
    v_and_b32 v174, 0xffff0000, v156
    v_and_b32 v175, 0xffff0000, v164
    v_mul_f32 v172, v172, v173
    v_mul_f32 v174, v174, v175
    v_cvt_pk_bf16_f32 v172, v172, v174
    v_lshlrev_b32 v173, 16, v172
    v_and_b32 v172, 0xffff0000, v172
    v_add_f32 v154, v154, v173
    v_add_f32 v154, v154, v172
    v_lshlrev_b32 v172, 16, v157
    v_lshlrev_b32 v173, 16, v165
    v_and_b32 v174, 0xffff0000, v157
    v_and_b32 v175, 0xffff0000, v165
    v_mul_f32 v172, v172, v173
    v_mul_f32 v174, v174, v175
    v_cvt_pk_bf16_f32 v172, v172, v174
    v_lshlrev_b32 v173, 16, v172
    v_and_b32 v172, 0xffff0000, v172
    v_add_f32 v154, v154, v173
    v_add_f32 v154, v154, v172
    v_lshlrev_b32 v172, 16, v158
    v_lshlrev_b32 v173, 16, v166
    v_and_b32 v174, 0xffff0000, v158
    v_and_b32 v175, 0xffff0000, v166
    v_mul_f32 v172, v172, v173
    v_mul_f32 v174, v174, v175
    v_cvt_pk_bf16_f32 v172, v172, v174
    v_lshlrev_b32 v173, 16, v172
    v_and_b32 v172, 0xffff0000, v172
    v_add_f32 v154, v154, v173
    v_add_f32 v154, v154, v172
    v_lshlrev_b32 v172, 16, v159
    v_lshlrev_b32 v173, 16, v167
    v_and_b32 v174, 0xffff0000, v159
    v_and_b32 v175, 0xffff0000, v167
    v_mul_f32 v172, v172, v173
    v_mul_f32 v174, v174, v175
    v_cvt_pk_bf16_f32 v172, v172, v174
    v_lshlrev_b32 v173, 16, v172
    v_and_b32 v172, 0xffff0000, v172
    v_add_f32 v154, v154, v173
    v_add_f32 v154, v154, v172
    v_lshlrev_b32 v172, 16, v160
    v_lshlrev_b32 v173, 16, v168
    v_and_b32 v174, 0xffff0000, v160
    v_and_b32 v175, 0xffff0000, v168
    v_mul_f32 v172, v172, v173
    v_mul_f32 v174, v174, v175
    v_cvt_pk_bf16_f32 v172, v172, v174
    v_lshlrev_b32 v173, 16, v172
    v_and_b32 v172, 0xffff0000, v172
    v_add_f32 v154, v154, v173
    v_add_f32 v154, v154, v172
    v_lshlrev_b32 v172, 16, v161
    v_lshlrev_b32 v173, 16, v169
    v_and_b32 v174, 0xffff0000, v161
    v_and_b32 v175, 0xffff0000, v169
    v_mul_f32 v172, v172, v173
    v_mul_f32 v174, v174, v175
    v_cvt_pk_bf16_f32 v172, v172, v174
    v_lshlrev_b32 v173, 16, v172
    v_and_b32 v172, 0xffff0000, v172
    v_add_f32 v154, v154, v173
    v_add_f32 v154, v154, v172
    v_lshlrev_b32 v172, 16, v162
    v_lshlrev_b32 v173, 16, v170
    v_and_b32 v174, 0xffff0000, v162
    v_and_b32 v175, 0xffff0000, v170
    v_mul_f32 v172, v172, v173
    v_mul_f32 v174, v174, v175
    v_cvt_pk_bf16_f32 v172, v172, v174
    v_lshlrev_b32 v173, 16, v172
    v_and_b32 v172, 0xffff0000, v172
    v_add_f32 v154, v154, v173
    v_add_f32 v154, v154, v172
    v_lshlrev_b32 v172, 16, v163
    v_lshlrev_b32 v173, 16, v171
    v_and_b32 v174, 0xffff0000, v163
    v_and_b32 v175, 0xffff0000, v171
    v_mul_f32 v172, v172, v173
    v_mul_f32 v174, v174, v175
    v_cvt_pk_bf16_f32 v172, v172, v174
    v_lshlrev_b32 v173, 16, v172
    v_and_b32 v172, 0xffff0000, v172
    v_add_f32 v154, v154, v173
    v_add_f32 v154, v154, v172
    s_nop 1
    v_add_f32_dpp v154, v154, v154 row_ror:8 row_mask:0xf bank_mask:0xf
    s_nop 1
    v_add_f32_dpp v154, v154, v154 row_ror:4 row_mask:0xf bank_mask:0xf
    s_nop 1
    v_add_f32_dpp v154, v154, v154 row_ror:2 row_mask:0xf bank_mask:0xf
    s_nop 1
    v_add_f32_dpp v154, v154, v154 row_ror:1 row_mask:0xf bank_mask:0xf
    v_mov_b32 v155, v154
    s_nop 1
    v_permlane32_swap_b32 v154, v155
    s_nop 1
    v_add_f32 v154, v154, v155
    v_mov_b32 v155, v154
    s_nop 1
    v_permlane16_swap_b32 v154, v155
    s_nop 1
    v_add_f32 v154, v154, v155
    v_cvt_pk_bf16_f32 v154, v154, v154
    v_and_b32 v154, 0xffff0000, v154
    v_mul_f32 v154, 0xbfb8aa3b, v154
    v_exp_f32 v154, v154
    s_nop 0
    v_add_f32 v154, 1.0, v154
    v_rcp_f32 v154, v154
    s_nop 0
    v_cvt_pk_bf16_f32 v154, v154, v154
    v_and_b32 v154, 0xffff0000, v154
    v_sub_f32 v155, 1.0, v154
    v_cvt_pk_bf16_f32 v155, v155, v155
    v_and_b32 v155, 0xffff0000, v155
    s_and_b32 s19, s78, 0xfffff800
    s_add_u32 s19, s19, 3145728
    v_add_u32 v153, s19, v108
    s_mov_b32 s77, 0x8000
L_sp15:
    global_load_dwordx4 v[112:115], v153, s[66:67] offset:0 sc1
    global_load_dwordx4 v[116:119], v153, s[66:67] offset:1024 sc1
    s_waitcnt vmcnt(0)
    v_max3_u32 v110, v119, v118, v117
    v_max3_u32 v110, v110, v116, v115
    v_max3_u32 v110, v110, v114, v113
    v_max_u32 v110, v110, v112
    v_cmp_eq_u32 vcc, -1, v110
    s_cbranch_vccz L_sd16
    s_sub_u32 s77, s77, 1
    s_cmp_lg_u32 s77, 0
    s_cbranch_scc1 L_sp15
L_sd16:
    v_add_u32 v153, 150144, v108
    ds_write_b128 v153, v[112:115]
    ds_write_b128 v153, v[116:119] offset:1024
    s_waitcnt lgkmcnt(0)
    s_barrier
    s_barrier
    v_lshlrev_b32 v152, 6, v0
    v_add_u32 v153, 131072, v152
    v_lshrrev_b32 v156, 3, v0
    v_lshlrev_b32 v157, 3, v156
    v_add_u32 v157, 147456, v157
    ds_read_b64 v[160:161], v157 offset:0
    ds_read_b64 v[162:163], v157 offset:64
    ds_read_b64 v[164:165], v157 offset:128
    ds_read_b64 v[166:167], v157 offset:192
    ds_read_b128 v[40:43], v153 offset:0
    ds_read_b128 v[44:47], v153 offset:16
    ds_read_b128 v[48:51], v153 offset:32
    ds_read_b128 v[52:55], v153 offset:48
    ds_read_b128 v[56:59], v153 offset:4096
    ds_read_b128 v[60:63], v153 offset:4112
    ds_read_b128 v[64:67], v153 offset:4128
    ds_read_b128 v[68:71], v153 offset:4144
    ds_read_b128 v[72:75], v153 offset:8192
    ds_read_b128 v[76:79], v153 offset:8208
    ds_read_b128 v[80:83], v153 offset:8224
    ds_read_b128 v[84:87], v153 offset:8240
    ds_read_b128 v[88:91], v153 offset:12288
    ds_read_b128 v[92:95], v153 offset:12304
    ds_read_b128 v[96:99], v153 offset:12320
    ds_read_b128 v[100:103], v153 offset:12336
    s_waitcnt lgkmcnt(0)
    v_max3_f32 v168, v160, v162, v164
    v_max_f32 v168, v168, v166
    v_sub_f32 v160, v160, v168
    v_mul_f32 v160, s72, v160
    v_exp_f32 v160, v160
    v_sub_f32 v162, v162, v168
    v_mul_f32 v162, s72, v162
    v_exp_f32 v162, v162
    v_sub_f32 v164, v164, v168
    v_mul_f32 v164, s72, v164
    v_exp_f32 v164, v164
    v_sub_f32 v166, v166, v168
    v_mul_f32 v166, s72, v166
    v_exp_f32 v166, v166
    s_nop 0
    v_mul_f32 v169, v160, v161
    v_fma_f32 v169, v162, v163, v169
    v_fma_f32 v169, v164, v165, v169
    v_fma_f32 v169, v166, v167, v169
    v_mul_f32 v40, v160, v40
    v_fma_f32 v40, v162, v56, v40
    v_fma_f32 v40, v164, v72, v40
    v_fma_f32 v40, v166, v88, v40
    v_mul_f32 v41, v160, v41
    v_fma_f32 v41, v162, v57, v41
    v_fma_f32 v41, v164, v73, v41
    v_fma_f32 v41, v166, v89, v41
    v_mul_f32 v42, v160, v42
    v_fma_f32 v42, v162, v58, v42
    v_fma_f32 v42, v164, v74, v42
    v_fma_f32 v42, v166, v90, v42
    v_mul_f32 v43, v160, v43
    v_fma_f32 v43, v162, v59, v43
    v_fma_f32 v43, v164, v75, v43
    v_fma_f32 v43, v166, v91, v43
    v_mul_f32 v44, v160, v44
    v_fma_f32 v44, v162, v60, v44
    v_fma_f32 v44, v164, v76, v44
    v_fma_f32 v44, v166, v92, v44
    v_mul_f32 v45, v160, v45
    v_fma_f32 v45, v162, v61, v45
    v_fma_f32 v45, v164, v77, v45
    v_fma_f32 v45, v166, v93, v45
    v_mul_f32 v46, v160, v46
    v_fma_f32 v46, v162, v62, v46
    v_fma_f32 v46, v164, v78, v46
    v_fma_f32 v46, v166, v94, v46
    v_mul_f32 v47, v160, v47
    v_fma_f32 v47, v162, v63, v47
    v_fma_f32 v47, v164, v79, v47
    v_fma_f32 v47, v166, v95, v47
    v_mul_f32 v48, v160, v48
    v_fma_f32 v48, v162, v64, v48
    v_fma_f32 v48, v164, v80, v48
    v_fma_f32 v48, v166, v96, v48
    v_mul_f32 v49, v160, v49
    v_fma_f32 v49, v162, v65, v49
    v_fma_f32 v49, v164, v81, v49
    v_fma_f32 v49, v166, v97, v49
    v_mul_f32 v50, v160, v50
    v_fma_f32 v50, v162, v66, v50
    v_fma_f32 v50, v164, v82, v50
    v_fma_f32 v50, v166, v98, v50
    v_mul_f32 v51, v160, v51
    v_fma_f32 v51, v162, v67, v51
    v_fma_f32 v51, v164, v83, v51
    v_fma_f32 v51, v166, v99, v51
    v_mul_f32 v52, v160, v52
    v_fma_f32 v52, v162, v68, v52
    v_fma_f32 v52, v164, v84, v52
    v_fma_f32 v52, v166, v100, v52
    v_mul_f32 v53, v160, v53
    v_fma_f32 v53, v162, v69, v53
    v_fma_f32 v53, v164, v85, v53
    v_fma_f32 v53, v166, v101, v53
    v_mul_f32 v54, v160, v54
    v_fma_f32 v54, v162, v70, v54
    v_fma_f32 v54, v164, v86, v54
    v_fma_f32 v54, v166, v102, v54
    v_mul_f32 v55, v160, v55
    v_fma_f32 v55, v162, v71, v55
    v_fma_f32 v55, v164, v87, v55
    v_fma_f32 v55, v166, v103, v55
    s_lshl_b32 s19, s4, 2
    s_add_u32 s19, s19, s6
    s_lshl_b32 s19, s19, 6
    s_add_u32 s19, s19, s7
    v_lshl_add_u32 v156, v156, 3, s19
    v_lshlrev_b32 v157, 3, v156
    v_add_u32 v157, 5242880, v157
    v_lshlrev_b32 v156, 9, v156
    v_and_b32 v158, 7, v0
    v_lshl_add_u32 v156, v158, 6, v156
    v_add_u32 v156, 4194304, v156
    v_min_u32 v40, -2, v40
    v_min_u32 v41, -2, v41
    v_min_u32 v42, -2, v42
    v_min_u32 v43, -2, v43
    v_min_u32 v44, -2, v44
    v_min_u32 v45, -2, v45
    v_min_u32 v46, -2, v46
    v_min_u32 v47, -2, v47
    v_min_u32 v48, -2, v48
    v_min_u32 v49, -2, v49
    v_min_u32 v50, -2, v50
    v_min_u32 v51, -2, v51
    v_min_u32 v52, -2, v52
    v_min_u32 v53, -2, v53
    v_min_u32 v54, -2, v54
    v_min_u32 v55, -2, v55
    v_min_u32 v168, -2, v168
    v_min_u32 v169, -2, v169
    global_store_dwordx4 v156, v[40:43], s[66:67] offset:0 sc1
    global_store_dwordx4 v156, v[44:47], s[66:67] offset:16 sc1
    global_store_dwordx4 v156, v[48:51], s[66:67] offset:32 sc1
    global_store_dwordx4 v156, v[52:55], s[66:67] offset:48 sc1
    global_store_dwordx2 v157, v[168:169], s[66:67] sc1
    s_lshl_b32 s19, s78, 4
    s_add_u32 s19, s19, 4194304
    v_add_u32 v111, s19, v108
    s_lshr_b32 s19, s78, 2
    s_add_u32 s19, s19, 5242880
    v_mov_b32 v109, s19
    s_mov_b32 s77, 0x8000
L_sp17:
    global_load_dwordx4 v[112:115], v111, s[66:67] offset:0 sc1
    global_load_dwordx4 v[116:119], v111, s[66:67] offset:1024 sc1
    global_load_dwordx4 v[120:123], v111, s[66:67] offset:2048 sc1
    global_load_dwordx4 v[124:127], v111, s[66:67] offset:3072 sc1
    global_load_dwordx4 v[40:43], v109, s[66:67] offset:0 sc1
    global_load_dwordx4 v[44:47], v109, s[66:67] offset:16 sc1
    global_load_dwordx4 v[48:51], v109, s[66:67] offset:32 sc1
    global_load_dwordx4 v[52:55], v109, s[66:67] offset:48 sc1
    s_waitcnt vmcnt(0)
    v_max3_u32 v110, v55, v54, v53
    v_max3_u32 v110, v110, v52, v51
    v_max3_u32 v110, v110, v50, v49
    v_max3_u32 v110, v110, v48, v47
    v_max3_u32 v110, v110, v46, v45
    v_max3_u32 v110, v110, v44, v43
    v_max3_u32 v110, v110, v42, v41
    v_max3_u32 v110, v110, v40, v127
    v_max3_u32 v110, v110, v126, v125
    v_max3_u32 v110, v110, v124, v123
    v_max3_u32 v110, v110, v122, v121
    v_max3_u32 v110, v110, v120, v119
    v_max3_u32 v110, v110, v118, v117
    v_max3_u32 v110, v110, v116, v115
    v_max3_u32 v110, v110, v114, v113
    v_max_u32 v110, v110, v112
    v_cmp_eq_u32 vcc, -1, v110
    s_cbranch_vccz L_sd18
    s_sub_u32 s77, s77, 1
    s_cmp_lg_u32 s77, 0
    s_cbranch_scc1 L_sp17
L_sd18:
    v_max3_f32 v56, v40, v42, v44
    v_max3_f32 v56, v56, v46, v48
    v_max3_f32 v56, v56, v50, v52
    v_max_f32 v56, v56, v54
    v_sub_f32 v40, v40, v56
    v_mul_f32 v40, s72, v40
    v_exp_f32 v40, v40
    v_sub_f32 v42, v42, v56
    v_mul_f32 v42, s72, v42
    v_exp_f32 v42, v42
    v_sub_f32 v44, v44, v56
    v_mul_f32 v44, s72, v44
    v_exp_f32 v44, v44
    v_sub_f32 v46, v46, v56
    v_mul_f32 v46, s72, v46
    v_exp_f32 v46, v46
    v_sub_f32 v48, v48, v56
    v_mul_f32 v48, s72, v48
    v_exp_f32 v48, v48
    v_sub_f32 v50, v50, v56
    v_mul_f32 v50, s72, v50
    v_exp_f32 v50, v50
    v_sub_f32 v52, v52, v56
    v_mul_f32 v52, s72, v52
    v_exp_f32 v52, v52
    v_sub_f32 v54, v54, v56
    v_mul_f32 v54, s72, v54
    v_exp_f32 v54, v54
    s_nop 0
    v_mul_f32 v57, v40, v41
    v_fma_f32 v57, v42, v43, v57
    v_fma_f32 v57, v44, v45, v57
    v_fma_f32 v57, v46, v47, v57
    v_fma_f32 v57, v48, v49, v57
    v_fma_f32 v57, v50, v51, v57
    v_fma_f32 v57, v52, v53, v57
    v_fma_f32 v57, v54, v55, v57
    v_rcp_f32 v57, v57
    v_cndmask_b32 v58, v42, v40, s[74:75]
    v_cndmask_b32 v59, v46, v44, s[74:75]
    v_cndmask_b32 v60, v50, v48, s[74:75]
    v_cndmask_b32 v61, v54, v52, s[74:75]
    v_mul_f32 v112, v58, v112
    v_mul_f32 v113, v58, v113
    v_mul_f32 v114, v58, v114
    v_mul_f32 v115, v58, v115
    v_mul_f32 v116, v59, v116
    v_mul_f32 v117, v59, v117
    v_mul_f32 v118, v59, v118
    v_mul_f32 v119, v59, v119
    v_mul_f32 v120, v60, v120
    v_mul_f32 v121, v60, v121
    v_mul_f32 v122, v60, v122
    v_mul_f32 v123, v60, v123
    v_mul_f32 v124, v61, v124
    v_mul_f32 v125, v61, v125
    v_mul_f32 v126, v61, v126
    v_mul_f32 v127, v61, v127
    v_add_f32 v112, v112, v116
    v_add_f32 v120, v120, v124
    v_add_f32 v113, v113, v117
    v_add_f32 v121, v121, v125
    v_add_f32 v114, v114, v118
    v_add_f32 v122, v122, v126
    v_add_f32 v115, v115, v119
    v_add_f32 v123, v123, v127
    v_add_f32 v112, v112, v120
    v_add_f32 v113, v113, v121
    v_add_f32 v114, v114, v122
    v_add_f32 v115, v115, v123
    v_mov_b32 v128, v112
    v_mov_b32 v129, v113
    v_mov_b32 v130, v114
    v_mov_b32 v131, v115
    s_nop 1
    v_permlane32_swap_b32 v112, v128
    v_permlane32_swap_b32 v113, v129
    v_permlane32_swap_b32 v114, v130
    v_permlane32_swap_b32 v115, v131
    s_nop 1
    v_add_f32 v112, v112, v128
    v_add_f32 v113, v113, v129
    v_add_f32 v114, v114, v130
    v_add_f32 v115, v115, v131
    v_mul_f32 v112, v57, v112
    v_mul_f32 v113, v57, v113
    v_mul_f32 v114, v57, v114
    v_mul_f32 v115, v57, v115
    v_cvt_pk_bf16_f32 v112, v112, v113
    v_cvt_pk_bf16_f32 v113, v114, v115
    v_min_u32 v112, -2, v112
    v_min_u32 v113, -2, v113
    s_add_u32 s19, s76, 6356992
    v_add_u32 v153, s19, v144
    s_lshr_b32 s19, s76, 5
    s_add_u32 s19, s19, 6422528
    v_mov_b32 v152, s19
    s_mov_b64 exec, s[74:75]
    global_store_dwordx2 v153, v[112:113], s[66:67] sc1
    s_mov_b64 exec, 1
    global_store_dwordx2 v152, v[154:155], s[66:67] sc1
    s_mov_b64 exec, -1
    s_lshl_b32 s19, s5, 11
    s_add_u32 s17, s19, 6356992
    v_add_u32 v153, s17, v108
    s_add_u32 s17, s19, 6291456
    v_add_u32 v156, s17, v108
    s_lshl_b32 s19, s5, 6
    s_add_u32 s19, s19, 6422528
    v_and_b32 v152, 7, v0
    v_lshlrev_b32 v152, 3, v152
    v_add_u32 v157, s19, v152
    s_mov_b32 s77, 0x8000
L_sp19:
    global_load_dwordx4 v[112:115], v153, s[66:67] offset:0 sc1
    global_load_dwordx4 v[116:119], v153, s[66:67] offset:1024 sc1
    global_load_dwordx2 v[120:121], v157, s[66:67] offset:0 sc1
    s_waitcnt vmcnt(0)
    v_max3_u32 v110, v121, v120, v119
    v_max3_u32 v110, v110, v118, v117
    v_max3_u32 v110, v110, v116, v115
    v_max3_u32 v110, v110, v114, v113
    v_max_u32 v110, v110, v112
    v_cmp_eq_u32 vcc, -1, v110
    s_cbranch_vccz L_sd20
    s_sub_u32 s77, s77, 1
    s_cmp_lg_u32 s77, 0
    s_cbranch_scc1 L_sp19
L_sd20:
    v_add_u32 v153, 152192, v108
    v_add_u32 v152, 156288, v152
    ds_write_b128 v153, v[112:115] offset:2048
    ds_write_b128 v153, v[116:119] offset:3072
    ds_write_b64 v152, v[120:121]
    v_lshlrev_b32 v158, 3, v0
    v_add_u32 v158, 147712, v158
    v_mov_b32 v159, 147712
    s_lshr_b32 s19, s5, 2
    s_lshl_b32 s19, s19, 11
    s_lshl_b32 s17, s4, 8
    s_add_u32 s19, s19, s17
    s_and_b32 s17, s5, 3
    s_lshl_b32 s17, s17, 6
    s_add_u32 s19, s19, s17
    v_lshlrev_b32 v143, 3, v0
    v_add_u32 v143, s19, v143
    s_waitcnt lgkmcnt(0)
    s_barrier
    ds_read_b64 v[160:161], v159 offset:512
    ds_read_b64 v[40:41], v158 offset:0
    ds_read_b64 v[162:163], v159 offset:1056
    ds_read_b64 v[42:43], v158 offset:544
    ds_read_b64 v[164:165], v159 offset:1600
    ds_read_b64 v[44:45], v158 offset:1088
    ds_read_b64 v[166:167], v159 offset:2144
    ds_read_b64 v[46:47], v158 offset:1632
    s_waitcnt lgkmcnt(0)
    v_max3_f32 v168, v160, v162, v164
    v_max_f32 v168, v168, v166
    v_sub_f32 v160, v160, v168
    v_mul_f32 v160, s72, v160
    v_exp_f32 v160, v160
    v_sub_f32 v162, v162, v168
    v_mul_f32 v162, s72, v162
    v_exp_f32 v162, v162
    v_sub_f32 v164, v164, v168
    v_mul_f32 v164, s72, v164
    v_exp_f32 v164, v164
    v_sub_f32 v166, v166, v168
    v_mul_f32 v166, s72, v166
    v_exp_f32 v166, v166
    s_nop 0
    v_mul_f32 v169, v160, v161
    v_fma_f32 v169, v162, v163, v169
    v_fma_f32 v169, v164, v165, v169
    v_fma_f32 v169, v166, v167, v169
    v_rcp_f32 v169, v169
    v_mul_f32 v40, v160, v40
    v_fma_f32 v40, v162, v42, v40
    v_fma_f32 v40, v164, v44, v40
    v_fma_f32 v40, v166, v46, v40
    v_mul_f32 v41, v160, v41
    v_fma_f32 v41, v162, v43, v41
    v_fma_f32 v41, v164, v45, v41
    v_fma_f32 v41, v166, v47, v41
    v_mul_f32 v40, v169, v40
    v_mul_f32 v41, v169, v41
    v_cvt_pk_bf16_f32 v40, v40, v41
    v_min_u32 v40, -2, v40
    global_store_dword v150, v40, s[66:67] sc1
    s_barrier
    s_mov_b32 s77, 0x8000
L_sp21:
    global_load_dwordx4 v[112:115], v156, s[66:67] offset:0 sc1
    global_load_dwordx4 v[116:119], v156, s[66:67] offset:1024 sc1
    s_waitcnt vmcnt(0)
    v_max3_u32 v110, v119, v118, v117
    v_max3_u32 v110, v110, v116, v115
    v_max3_u32 v110, v110, v114, v113
    v_max_u32 v110, v110, v112
    v_cmp_eq_u32 vcc, -1, v110
    s_cbranch_vccz L_sd22
    s_sub_u32 s77, s77, 1
    s_cmp_lg_u32 s77, 0
    s_cbranch_scc1 L_sp21
L_sd22:
    ds_write_b128 v153, v[112:115]
    ds_write_b128 v153, v[116:119] offset:1024
    s_waitcnt lgkmcnt(0)
    s_barrier
    s_mov_b32 s77, 0x8000
L_sp23:
    global_load_dwordx4 v[112:115], v151, s[66:67] offset:0 sc1
    global_load_dwordx4 v[116:119], v151, s[66:67] offset:1024 sc1
    global_load_dwordx4 v[120:123], v151, s[66:67] offset:2048 sc1
    global_load_dwordx4 v[124:127], v151, s[66:67] offset:3072 sc1
    s_waitcnt vmcnt(0)
    v_max3_u32 v110, v127, v126, v125
    v_max3_u32 v110, v110, v124, v123
    v_max3_u32 v110, v110, v122, v121
    v_max3_u32 v110, v110, v120, v119
    v_max3_u32 v110, v110, v118, v117
    v_max3_u32 v110, v110, v116, v115
    v_max3_u32 v110, v110, v114, v113
    v_max_u32 v110, v110, v112
    v_cmp_eq_u32 vcc, -1, v110
    s_cbranch_vccz L_sd24
    s_sub_u32 s77, s77, 1
    s_cmp_lg_u32 s77, 0
    s_cbranch_scc1 L_sp23
L_sd24:
    v_add_f32 v112, v112, v116
    v_add_f32 v120, v120, v124
    v_add_f32 v113, v113, v117
    v_add_f32 v121, v121, v125
    v_add_f32 v114, v114, v118
    v_add_f32 v122, v122, v126
    v_add_f32 v115, v115, v119
    v_add_f32 v123, v123, v127
    v_add_f32 v112, v112, v120
    v_add_f32 v113, v113, v121
    v_add_f32 v114, v114, v122
    v_add_f32 v115, v115, v123
    v_mov_b32 v128, v112
    v_mov_b32 v129, v113
    v_mov_b32 v130, v114
    v_mov_b32 v131, v115
    s_nop 1
    v_permlane32_swap_b32 v112, v128
    v_permlane32_swap_b32 v113, v129
    v_permlane32_swap_b32 v114, v130
    v_permlane32_swap_b32 v115, v131
    s_nop 1
    v_add_f32 v112, v112, v128
    v_add_f32 v113, v113, v129
    v_add_f32 v114, v114, v130
    v_add_f32 v115, v115, v131
    v_mov_b32 v128, v112
    v_mov_b32 v129, v113
    v_mov_b32 v130, v114
    v_mov_b32 v131, v115
    s_nop 1
    v_permlane16_swap_b32 v112, v128
    v_permlane16_swap_b32 v113, v129
    v_permlane16_swap_b32 v114, v130
    v_permlane16_swap_b32 v115, v131
    s_nop 1
    v_add_f32 v112, v112, v128
    v_add_f32 v113, v113, v129
    v_add_f32 v114, v114, v130
    v_add_f32 v115, v115, v131
    s_nop 1
    v_add_f32_dpp v112, v112, v112 row_ror:8 row_mask:0xf bank_mask:0xf
    v_add_f32_dpp v113, v113, v113 row_ror:8 row_mask:0xf bank_mask:0xf
    v_add_f32_dpp v114, v114, v114 row_ror:8 row_mask:0xf bank_mask:0xf
    v_add_f32_dpp v115, v115, v115 row_ror:8 row_mask:0xf bank_mask:0xf
    v_cvt_pk_bf16_f32 v112, v112, v113
    v_cvt_pk_bf16_f32 v113, v114, v115
    s_mov_b64 exec, 0xff
    global_store_dwordx2 v143, v[112:113], s[62:63]
    s_cmp_lg_u32 s2, 0
    s_cbranch_scc1 L_noep
    s_mov_b64 exec, 1
    v_mov_b32 v1, 0xf0000
    v_mov_b32 v2, s79
    global_store_dword v1, v2, s[66:67] sc1
L_noep:
L_end:
    s_endpgm
.section .rodata,"a"
.p2align 6
.amdhsa_kernel gated_mix__mha_block_cached__gqa_block_cached__decode_kernel
  .amdhsa_next_free_vgpr 256
  .amdhsa_next_free_sgpr 100
  .amdhsa_accum_offset 256
  .amdhsa_group_segment_fixed_size 0
  .amdhsa_kernarg_size 112
  .amdhsa_user_sgpr_count 2
  .amdhsa_user_sgpr_kernarg_segment_ptr 1
  .amdhsa_system_sgpr_workgroup_id_x 1
.end_amdhsa_kernel
```
